```python
import torch

def _softmax(x, axis=-1):
    return torch.softmax(x, dim=axis)
def _gelu(x):
    return torch.nn.functional.gelu(x, approximate="tanh")
def _silu(x):
    return torch.nn.functional.silu(x)
def _sigmoid(x):
    return torch.sigmoid(x)
def _layernorm(x, axis=-1, eps=1e-5):
    m = x.mean(dim=axis, keepdim=True)
    v = x.var(dim=axis, keepdim=True, unbiased=False)
    return (x - m) / torch.sqrt(v + eps)
def _scatter_add(tgt, idx, src, axis=0):
    return tgt.clone().index_add_(axis, idx, src)
def _segment_sum(src, seg, n):
    out = torch.zeros((n,) + src.shape[1:], dtype=src.dtype)
    return out.index_add_(0, seg, src)
def _pad(x, pw):
    flat = tuple(v for pair in reversed(pw) for v in pair)
    return torch.nn.functional.pad(x, flat)

kernel_name = 'standalone__glu_gated_geglu__prompt'

def setup_inputs():

    _w = (lambda a: (lambda t: t.to(torch.bfloat16) if t.is_floating_point() else t)(torch.as_tensor(a)))
    B, S, Dm, Df = 1, 2048, 512, 1792
    return {
        "x": _w((lambda *s: torch.randn(*s, dtype=torch.bfloat16) * 0.05)(B, S, Dm)),
        "w_gate": _w((lambda *s: torch.randn(*s, dtype=torch.bfloat16) * 0.05)(Dm, Df) * (Dm ** -0.5)),
        "w_up": _w((lambda *s: torch.randn(*s, dtype=torch.bfloat16) * 0.05)(Dm, Df) * (Dm ** -0.5)),
        "w_down": _w((lambda *s: torch.randn(*s, dtype=torch.bfloat16) * 0.05)(Df, Dm) * (Df ** -0.5)),
    }

def reference(x, w_gate, w_up, w_down):
    g = torch.einsum("bsd,df->bsf", x, w_gate)
    u = torch.einsum("bsd,df->bsf", x, w_up)
    h = _gelu(g) * u
    return torch.einsum("bsf,fd->bsd", h, w_down)
```

```asm
; @launch grid=(256,1,1) block=(512,1,1) lds=163840
.amdgcn_target "amdgcn-amd-amdhsa--gfx950"
.text
.globl standalone__glu_gated_geglu__prompt_kernel
.p2align 12
.p2align 8
.type standalone__glu_gated_geglu__prompt_kernel,@function
standalone__glu_gated_geglu__prompt_kernel:
    s_cmp_lt_u32 s2, 256
    s_cbranch_scc0 L_exit
    s_load_dwordx2 s[20:21], s[0:1], 0
    s_load_dwordx2 s[24:25], s[0:1], 8
    s_load_dwordx2 s[28:29], s[0:1], 16
    v_lshrrev_b32 v1, 6, v0
    v_and_b32 v127, 63, v0
    v_readfirstlane_b32 s3, v1
    s_and_b32 s48, s2, 7
    s_lshr_b32 s49, s2, 3
    s_and_b32 s53, s49, 3
    s_lshr_b32 s52, s49, 2
    s_sub_u32 s52, s52, 1
    s_and_b32 s50, s48, 1
    s_lshl2_add_u32 s50, s50, s53
    s_lshr_b32 s59, s48, 1
    s_mul_i32 s51, s59, 7
    s_add_u32 s51, s51, s52
    s_and_b32 s60, s3, 3
    s_mov_b32 s23, 0x20000
    s_lshl_b32 s22, s23, 4
    s_cmp_ge_u32 s3, 4
    s_cbranch_scc0 L_loader
    s_getpc_b64 s[68:69]
L_pc:
    s_mov_b32 s70, L_exit-L_pc
    s_mov_b32 s71, s23
    s_lshl2_add_u32 s56, s49, s60
    s_lshl_b32 s56, s56, 8
    v_lshlrev_b32 v1, 7, v127
    s_mov_b64 exec, 3
    buffer_load_dword v8, v1, s[68:71], s56 offen
    s_branch L_p1
L_loader:
    s_mov_b32 s26, 1835008
    s_mov_b32 s27, s23
    s_mov_b64 s[30:31], s[26:27]
    v_lshrrev_b32 v1, 3, v127
    v_and_b32 v2, 7, v127
    v_lshrrev_b32 v3, 4, v127
    v_xor_b32 v4, v2, v3
    v_lshlrev_b32 v5, 10, v1
    v_lshl_add_u32 v48, v4, 4, v5
    s_movk_i32 s56, 7168
    v_xad_u32 v49, v48, 64, s56
    v_xad_u32 v50, v49, 64, s56
    v_xad_u32 v51, v50, 64, s56
    v_and_b32 v6, 2, v1
    v_xor_b32 v6, v2, v6
    v_mul_u32_u24 v7, 3584, v1
    v_lshl_add_u32 v52, v6, 4, v7
    s_movk_i32 s56, 27648
    v_xad_u32 v53, v52, 64, s56
    s_lshl1_add_u32 s56, s48, s59
    s_add_u32 s57, s53, s52
    s_lshl2_add_u32 s62, s57, s56
    s_lshl3_add_u32 s63, s50, s60
    s_lshl_b32 s63, s63, 15
    s_mul_i32 s64, s60, 448
    s_add_u32 s64, s64, s51
    s_lshl_b32 s64, s64, 7
    s_lshl_b32 s7, s60, 12
    s_mov_b32 s17, 0
    s_mov_b32 s58, s62
    s_and_b32 s58, s58, 7
    s_mul_i32 s57, s58, 229376
    s_add_u32 s57, s57, s64
    s_lshl_b32 s58, s58, 7
    s_add_u32 s11, s58, s63
    s_add_u32 m0, s7, 16384
    s_cmp_lt_u32 s49, 4
    s_cbranch_scc1 L_late
    s_waitcnt lgkmcnt(0)
    buffer_load_dwordx4 v52, s[24:27], s57 offen lds
    s_mov_b32 s56, s11
    buffer_load_dwordx4 v53, s[24:27], s57 offen offset:1024 lds
    s_add_u32 m0, s7, 18432
    s_add_u32 s17, s17, 1
    buffer_load_dwordx4 v52, s[28:31], s57 offen lds
    buffer_load_dwordx4 v53, s[28:31], s57 offen offset:1024 lds
    s_mov_b32 m0, s7
    s_add_u32 s58, s62, s17
    buffer_load_dwordx4 v48, s[20:23], s56 offen offset:0 lds
    s_and_b32 s58, s58, 7
    s_mul_i32 s57, s58, 229376
    s_add_u32 s57, s57, s64
    buffer_load_dwordx4 v49, s[20:23], s56 offen offset:1024 lds
    s_lshl_b32 s58, s58, 7
    s_add_u32 s11, s58, s63
    s_add_u32 s7, s7, 32768
    buffer_load_dwordx4 v50, s[20:23], s56 offen offset:2048 lds
    s_sub_u32 s58, s7, 98304
    s_cselect_b32 s7, s7, s58
    buffer_load_dwordx4 v51, s[20:23], s56 offen offset:3072 lds
    s_add_u32 m0, s7, 16384
L_late:
    s_load_dwordx2 s[32:33], s[0:1], 24
    s_load_dwordx2 s[40:41], s[0:1], 32
    s_load_dwordx2 s[44:45], s[0:1], 40
    s_load_dwordx2 s[36:37], s[0:1], 48
    s_mov_b32 s34, 1835008
    s_mov_b32 s35, 0x20000
    s_mov_b32 s38, 268435456
    s_mov_b32 s39, 0x20000
    s_mov_b32 s42, 2097152
    s_mov_b32 s43, 0x20000
    s_mov_b32 s46, 256
    s_mov_b32 s47, 0x20000
    s_lshr_b32 s55, s49, 2
    s_and_b32 s54, s52, 3
    s_cmp_lt_u32 s55, 4
    s_cselect_b32 s55, s54, s55
    s_mov_b32 s54, s53
    v_lshl_add_u32 v64, v6, 4, v5
    s_movk_i32 s8, 7168
    v_xad_u32 v65, v64, 64, s8
    v_xad_u32 v66, v65, 64, s8
    v_xad_u32 v67, v66, 64, s8
    s_and_b32 s8, s60, 1
    s_lshl3_add_u32 s19, s50, s8
    s_add_u32 s19, s19, 4
    s_lshl_b32 s19, s19, 15
    s_lshl_b32 s65, s60, 14
    s_add_u32 s65, s65, 98304
    s_mul_i32 s66, s60, 458752
    s_lshl_b32 s8, s55, 7
    s_add_u32 s66, s66, s8
    s_mul_i32 s67, s48, 917504
    s_mul_i32 s8, s60, 14336
    s_add_u32 s67, s67, s8
    s_add_u32 s67, s67, 1048576
    s_mul_i32 s8, s54, 57344
    s_add_u32 s67, s67, s8
    s_lshl2_add_u32 s18, s48, s60
    s_mul_i32 s18, s18, 17408
    s_lshr_b32 s8, s48, 1
    s_lshl2_add_u32 s16, s50, s8
    s_mul_i32 s16, s16, 17408
    s_mov_b32 s14, 1
    s_mul_i32 s8, s48, 2
    s_sub_u32 s9, s8, 14
    s_cselect_b32 s8, s8, s9
    s_lshl_b32 s68, s8, 10
    s_movk_i32 s9, 1024
    s_add_u32 s8, s68, s9
    s_cmpk_eq_u32 s8, 14336
    s_cselect_b32 s69, 0, s8
    s_add_u32 s8, s69, s9
    s_cmpk_eq_u32 s8, 14336
    s_cselect_b32 s70, 0, s8
    s_add_u32 s8, s70, s9
    s_cmpk_eq_u32 s8, 14336
    s_cselect_b32 s71, 0, s8
    s_add_u32 s8, s71, s9
    s_cmpk_eq_u32 s8, 14336
    s_cselect_b32 s72, 0, s8
    s_add_u32 s8, s72, s9
    s_cmpk_eq_u32 s8, 14336
    s_cselect_b32 s73, 0, s8
    s_add_u32 s8, s73, s9
    s_cmpk_eq_u32 s8, 14336
    s_cselect_b32 s74, 0, s8
    s_add_u32 s8, s74, s9
    s_cmpk_eq_u32 s8, 14336
    s_cselect_b32 s75, 0, s8
    s_add_u32 s8, s75, s9
    s_cmpk_eq_u32 s8, 14336
    s_cselect_b32 s76, 0, s8
    s_add_u32 s8, s76, s9
    s_cmpk_eq_u32 s8, 14336
    s_cselect_b32 s77, 0, s8
    s_add_u32 s8, s77, s9
    s_cmpk_eq_u32 s8, 14336
    s_cselect_b32 s78, 0, s8
    s_add_u32 s8, s78, s9
    s_cmpk_eq_u32 s8, 14336
    s_cselect_b32 s79, 0, s8
    s_add_u32 s8, s79, s9
    s_cmpk_eq_u32 s8, 14336
    s_cselect_b32 s80, 0, s8
    s_add_u32 s8, s80, s9
    s_cmpk_eq_u32 s8, 14336
    s_cselect_b32 s81, 0, s8
    v_lshlrev_b32 v120, 4, v127
    v_add_u32 v120, s67, v120
    v_lshrrev_b32 v1, 4, v127
    v_bfe_u32 v2, v127, 2, 2
    v_bfe_u32 v3, v127, 1, 1
    v_and_b32 v4, 1, v127
    v_and_b32 v5, 2, v2
    v_and_b32 v6, 1, v1
    v_lshl_or_b32 v5, v6, 2, v5
    v_or_b32 v5, v5, v3
    v_lshl_add_u32 v6, v1, 3, v2
    v_lshlrev_b32 v6, 7, v6
    v_lshl_add_u32 v6, v5, 4, v6
    v_lshl_add_u32 v6, v4, 3, v6
    v_add_u32 v124, s65, v6
    v_and_b32 v2, 15, v127
    v_xor_b32 v3, v1, v2
    v_lshlrev_b32 v3, 4, v3
    v_lshl_add_u32 v3, v2, 8, v3
    s_lshl_b32 s8, s60, 12
    v_add_u32 v123, s8, v3
    v_xor_b32 v125, 32, v124
    v_xor_b32 v126, 64, v124
    v_xor_b32 v127, 96, v124
    s_waitcnt lgkmcnt(0)
    s_cmp_lt_u32 s49, 4
    s_cbranch_scc1 L_loader_idle
L_pass0:
    buffer_load_dwordx4 v52, s[24:27], s57 offen lds
    s_mov_b32 s56, s11
    buffer_load_dwordx4 v53, s[24:27], s57 offen offset:1024 lds
    s_add_u32 m0, s7, 18432
    s_add_u32 s17, s17, 1
    buffer_load_dwordx4 v52, s[28:31], s57 offen lds
    buffer_load_dwordx4 v53, s[28:31], s57 offen offset:1024 lds
    s_mov_b32 m0, s7
    s_add_u32 s58, s62, s17
    buffer_load_dwordx4 v48, s[20:23], s56 offen offset:0 lds
    s_and_b32 s58, s58, 7
    s_mul_i32 s57, s58, 229376
    s_add_u32 s57, s57, s64
    buffer_load_dwordx4 v49, s[20:23], s56 offen offset:1024 lds
    s_lshl_b32 s58, s58, 7
    s_add_u32 s11, s58, s63
    s_add_u32 s7, s7, 32768
    buffer_load_dwordx4 v50, s[20:23], s56 offen offset:2048 lds
    s_sub_u32 s58, s7, 98304
    s_cselect_b32 s7, s7, s58
    buffer_load_dwordx4 v51, s[20:23], s56 offen offset:3072 lds
    s_add_u32 m0, s7, 16384
    s_cmp_lt_u32 s17, 8
    s_waitcnt vmcnt(8)
    s_barrier
    s_cbranch_scc1 L_pass0
    s_lshr_b32 s56, s60, 1
    s_add_u32 s62, s62, s56
    s_lshl_b32 s62, s62, 7
    s_lshl_b32 s7, s60, 12
    s_add_u32 m0, s7, 65536
    s_and_b32 s56, s62, 0x380
    s_add_u32 s56, s56, s19
    buffer_load_dwordx4 v48, s[20:23], s56 offen offset:0 lds
    s_addk_i32 s62, 256
    buffer_load_dwordx4 v49, s[20:23], s56 offen offset:1024 lds
    buffer_load_dwordx4 v50, s[20:23], s56 offen offset:2048 lds
    buffer_load_dwordx4 v51, s[20:23], s56 offen offset:3072 lds
    s_add_u32 m0, s7, 81920
    s_and_b32 s56, s62, 0x380
    s_add_u32 s56, s56, s19
    buffer_load_dwordx4 v48, s[20:23], s56 offen offset:0 lds
    s_addk_i32 s62, 256
    buffer_load_dwordx4 v49, s[20:23], s56 offen offset:1024 lds
    buffer_load_dwordx4 v50, s[20:23], s56 offen offset:2048 lds
    buffer_load_dwordx4 v51, s[20:23], s56 offen offset:3072 lds
    s_add_u32 m0, s65, 0
    s_lshl_b32 s58, s68, 5
    s_add_u32 s58, s58, s66
    buffer_load_dwordx4 v64, s[32:35], s58 offen offset:0 lds
    buffer_load_dwordx4 v65, s[32:35], s58 offen offset:1024 lds
    s_waitcnt vmcnt(10)
    s_barrier
    s_add_u32 m0, s7, 0
    s_and_b32 s56, s62, 0x380
    s_add_u32 s56, s56, s19
    buffer_load_dwordx4 v48, s[20:23], s56 offen offset:0 lds
    s_addk_i32 s62, 256
    buffer_load_dwordx4 v49, s[20:23], s56 offen offset:1024 lds
    buffer_load_dwordx4 v50, s[20:23], s56 offen offset:2048 lds
    buffer_load_dwordx4 v51, s[20:23], s56 offen offset:3072 lds
    s_add_u32 m0, s7, 16384
    s_and_b32 s56, s62, 0x380
    s_add_u32 s56, s56, s19
    buffer_load_dwordx4 v48, s[20:23], s56 offen offset:0 lds
    s_addk_i32 s62, 256
    s_add_u32 s19, s19, 65536
    buffer_load_dwordx4 v49, s[20:23], s56 offen offset:1024 lds
    buffer_load_dwordx4 v50, s[20:23], s56 offen offset:2048 lds
    buffer_load_dwordx4 v51, s[20:23], s56 offen offset:3072 lds
    s_add_u32 m0, s65, 0
    s_lshl_b32 s58, s68, 5
    s_add_u32 s58, s58, s66
    buffer_load_dwordx4 v66, s[32:35], s58 offen offset:2048 lds
    buffer_load_dwordx4 v67, s[32:35], s58 offen offset:3072 lds
    s_waitcnt vmcnt(12)
    s_barrier
    s_load_dword s10, s[44:45], 0
    s_add_u32 m0, s7, 32768
    s_and_b32 s56, s62, 0x380
    s_add_u32 s56, s56, s19
    buffer_load_dwordx4 v48, s[20:23], s56 offen offset:0 lds
    s_addk_i32 s62, 256
    buffer_load_dwordx4 v49, s[20:23], s56 offen offset:1024 lds
    buffer_load_dwordx4 v50, s[20:23], s56 offen offset:2048 lds
    buffer_load_dwordx4 v51, s[20:23], s56 offen offset:3072 lds
    s_add_u32 m0, s7, 49152
    s_and_b32 s56, s62, 0x380
    s_add_u32 s56, s56, s19
    buffer_load_dwordx4 v48, s[20:23], s56 offen offset:0 lds
    s_addk_i32 s62, 256
    buffer_load_dwordx4 v49, s[20:23], s56 offen offset:1024 lds
    buffer_load_dwordx4 v50, s[20:23], s56 offen offset:2048 lds
    buffer_load_dwordx4 v51, s[20:23], s56 offen offset:3072 lds
    s_waitcnt vmcnt(8)
    ds_read_b64_tr_b16 a[0:1], v124 offset:0
    ds_read_b64_tr_b16 a[2:3], v124 offset:512
    s_add_u32 m0, s65, 4096
    s_lshl_b32 s58, s69, 5
    s_add_u32 s58, s58, s66
    buffer_load_dwordx4 v64, s[32:35], s58 offen offset:0 lds
    ds_read_b64_tr_b16 a[4:5], v125 offset:0
    ds_read_b64_tr_b16 a[6:7], v125 offset:512
    buffer_load_dwordx4 v65, s[32:35], s58 offen offset:1024 lds
    ds_read_b64_tr_b16 a[8:9], v126 offset:0
    ds_read_b64_tr_b16 a[10:11], v126 offset:512
    buffer_load_dwordx4 v66, s[32:35], s58 offen offset:2048 lds
    ds_read_b64_tr_b16 a[12:13], v127 offset:0
    ds_read_b64_tr_b16 a[14:15], v127 offset:512
    buffer_load_dwordx4 v67, s[32:35], s58 offen offset:3072 lds
    s_add_u32 m0, s65, 8192
    s_lshl_b32 s58, s70, 5
    s_add_u32 s58, s58, s66
    buffer_load_dwordx4 v64, s[32:35], s58 offen offset:0 lds
    buffer_load_dwordx4 v65, s[32:35], s58 offen offset:1024 lds
    buffer_load_dwordx4 v66, s[32:35], s58 offen offset:2048 lds
    buffer_load_dwordx4 v67, s[32:35], s58 offen offset:3072 lds
    s_add_u32 m0, s65, 12288
    s_lshl_b32 s58, s71, 5
    s_add_u32 s58, s58, s66
    buffer_load_dwordx4 v64, s[32:35], s58 offen offset:0 lds
    buffer_load_dwordx4 v65, s[32:35], s58 offen offset:1024 lds
    s_waitcnt vmcnt(10)
    s_waitcnt lgkmcnt(0)
    s_cmp_eq_u32 s10, 1
    s_cbranch_scc0 L_rdy_retry
L_rdy_ok:
    s_barrier
    s_add_u32 m0, s7, 65536
    s_and_b32 s56, s62, 0x380
    s_add_u32 s56, s56, s19
    buffer_load_dwordx4 v48, s[20:23], s56 offen offset:0 lds
    s_addk_i32 s62, 256
    buffer_load_dwordx4 v49, s[20:23], s56 offen offset:1024 lds
    s_waitcnt vmcnt(8)
    ds_read_b64_tr_b16 a[16:17], v124 offset:4096
    ds_read_b64_tr_b16 a[18:19], v124 offset:4608
    buffer_load_dwordx4 v50, s[20:23], s56 offen offset:2048 lds
    ds_read_b64_tr_b16 a[20:21], v125 offset:4096
    ds_read_b64_tr_b16 a[22:23], v125 offset:4608
    buffer_load_dwordx4 v51, s[20:23], s56 offen offset:3072 lds
    ds_read_b64_tr_b16 a[24:25], v126 offset:4096
    ds_read_b64_tr_b16 a[26:27], v126 offset:4608
    s_add_u32 m0, s7, 81920
    s_and_b32 s56, s62, 0x380
    s_add_u32 s56, s56, s19
    buffer_load_dwordx4 v48, s[20:23], s56 offen offset:0 lds
    s_addk_i32 s62, 256
    ds_read_b64_tr_b16 a[28:29], v127 offset:4096
    ds_read_b64_tr_b16 a[30:31], v127 offset:4608
    buffer_load_dwordx4 v49, s[20:23], s56 offen offset:1024 lds
    s_waitcnt vmcnt(8)
    ds_read_b64_tr_b16 a[32:33], v124 offset:8192
    ds_read_b64_tr_b16 a[34:35], v124 offset:8704
    buffer_load_dwordx4 v50, s[20:23], s56 offen offset:2048 lds
    ds_read_b64_tr_b16 a[36:37], v125 offset:8192
    ds_read_b64_tr_b16 a[38:39], v125 offset:8704
    buffer_load_dwordx4 v51, s[20:23], s56 offen offset:3072 lds
    ds_read_b64_tr_b16 a[40:41], v126 offset:8192
    ds_read_b64_tr_b16 a[42:43], v126 offset:8704
    s_add_u32 m0, s65, 12288
    s_lshl_b32 s58, s71, 5
    s_add_u32 s58, s58, s66
    buffer_load_dwordx4 v66, s[32:35], s58 offen offset:2048 lds
    ds_read_b64_tr_b16 a[44:45], v127 offset:8192
    ds_read_b64_tr_b16 a[46:47], v127 offset:8704
    buffer_load_dwordx4 v67, s[32:35], s58 offen offset:3072 lds
    s_add_u32 m0, s65, 0
    s_lshl_b32 s58, s72, 5
    s_add_u32 s58, s58, s66
    buffer_load_dwordx4 v64, s[32:35], s58 offen offset:0 lds
    buffer_load_dwordx4 v65, s[32:35], s58 offen offset:1024 lds
    buffer_load_dwordx4 v66, s[32:35], s58 offen offset:2048 lds
    buffer_load_dwordx4 v67, s[32:35], s58 offen offset:3072 lds
    s_waitcnt lgkmcnt(8)
    s_add_u32 m0, s65, 4096
    s_lshl_b32 s58, s73, 5
    s_add_u32 s58, s58, s66
    buffer_load_dwordx4 v64, s[32:35], s58 offen offset:0 lds
    buffer_load_dwordx4 v65, s[32:35], s58 offen offset:1024 lds
    buffer_load_dwordx4 v66, s[32:35], s58 offen offset:2048 lds
    buffer_load_dwordx4 v67, s[32:35], s58 offen offset:3072 lds
    s_waitcnt vmcnt(8)
    ds_read_b64_tr_b16 a[48:49], v124 offset:12288
    ds_read_b64_tr_b16 a[50:51], v124 offset:12800
    s_waitcnt lgkmcnt(2)
    s_add_u32 m0, s65, 8192
    s_lshl_b32 s58, s74, 5
    s_add_u32 s58, s58, s66
    buffer_load_dwordx4 v64, s[32:35], s58 offen offset:0 lds
    ds_read_b64_tr_b16 a[52:53], v125 offset:12288
    ds_read_b64_tr_b16 a[54:55], v125 offset:12800
    buffer_load_dwordx4 v65, s[32:35], s58 offen offset:1024 lds
    ds_read_b64_tr_b16 a[56:57], v126 offset:12288
    ds_read_b64_tr_b16 a[58:59], v126 offset:12800
    buffer_load_dwordx4 v66, s[32:35], s58 offen offset:2048 lds
    ds_read_b64_tr_b16 a[60:61], v127 offset:12288
    ds_read_b64_tr_b16 a[62:63], v127 offset:12800
    buffer_load_dwordx4 v67, s[32:35], s58 offen offset:3072 lds
    s_waitcnt vmcnt(8)
    ds_read_b64_tr_b16 a[64:65], v124 offset:0
    ds_read_b64_tr_b16 a[66:67], v124 offset:512
    s_waitcnt lgkmcnt(2)
    s_add_u32 m0, s65, 12288
    s_lshl_b32 s58, s75, 5
    s_add_u32 s58, s58, s66
    buffer_load_dwordx4 v64, s[32:35], s58 offen offset:0 lds
    ds_read_b64_tr_b16 a[68:69], v125 offset:0
    ds_read_b64_tr_b16 a[70:71], v125 offset:512
    buffer_load_dwordx4 v65, s[32:35], s58 offen offset:1024 lds
    ds_read_b64_tr_b16 a[72:73], v126 offset:0
    ds_read_b64_tr_b16 a[74:75], v126 offset:512
    buffer_load_dwordx4 v66, s[32:35], s58 offen offset:2048 lds
    ds_read_b64_tr_b16 a[76:77], v127 offset:0
    ds_read_b64_tr_b16 a[78:79], v127 offset:512
    buffer_load_dwordx4 v67, s[32:35], s58 offen offset:3072 lds
    s_waitcnt vmcnt(8)
    ds_read_b64_tr_b16 a[80:81], v124 offset:4096
    ds_read_b64_tr_b16 a[82:83], v124 offset:4608
    s_waitcnt lgkmcnt(2)
    s_add_u32 m0, s65, 0
    s_lshl_b32 s58, s76, 5
    s_add_u32 s58, s58, s66
    buffer_load_dwordx4 v64, s[32:35], s58 offen offset:0 lds
    ds_read_b64_tr_b16 a[84:85], v125 offset:4096
    ds_read_b64_tr_b16 a[86:87], v125 offset:4608
    s_barrier
    s_cmp_lg_u32 s60, 0
    s_cbranch_scc1 L_nosig
    s_add_u32 s15, s16, 4352
    s_atomic_add s14, s[36:37], s15
L_nosig:
L_loader_join:
    buffer_load_dwordx4 v65, s[32:35], s58 offen offset:1024 lds
    ds_read_b64_tr_b16 a[88:89], v126 offset:4096
    ds_read_b64_tr_b16 a[90:91], v126 offset:4608
    buffer_load_dwordx4 v66, s[32:35], s58 offen offset:2048 lds
    ds_read_b64_tr_b16 a[92:93], v127 offset:4096
    ds_read_b64_tr_b16 a[94:95], v127 offset:4608
    buffer_load_dwordx4 v67, s[32:35], s58 offen offset:3072 lds
    s_waitcnt vmcnt(8)
    ds_read_b64_tr_b16 a[96:97], v124 offset:8192
    ds_read_b64_tr_b16 a[98:99], v124 offset:8704
    s_waitcnt lgkmcnt(2)
    s_add_u32 m0, s65, 4096
    s_lshl_b32 s58, s77, 5
    s_add_u32 s58, s58, s66
    buffer_load_dwordx4 v64, s[32:35], s58 offen offset:0 lds
    ds_read_b64_tr_b16 a[100:101], v125 offset:8192
    ds_read_b64_tr_b16 a[102:103], v125 offset:8704
    buffer_load_dwordx4 v65, s[32:35], s58 offen offset:1024 lds
    ds_read_b64_tr_b16 a[104:105], v126 offset:8192
    ds_read_b64_tr_b16 a[106:107], v126 offset:8704
    buffer_load_dwordx4 v66, s[32:35], s58 offen offset:2048 lds
    ds_read_b64_tr_b16 a[108:109], v127 offset:8192
    ds_read_b64_tr_b16 a[110:111], v127 offset:8704
    buffer_load_dwordx4 v67, s[32:35], s58 offen offset:3072 lds
    s_waitcnt vmcnt(8)
    ds_read_b64_tr_b16 a[112:113], v124 offset:12288
    ds_read_b64_tr_b16 a[114:115], v124 offset:12800
    s_waitcnt lgkmcnt(2)
    s_add_u32 m0, s65, 8192
    s_lshl_b32 s58, s78, 5
    s_add_u32 s58, s58, s66
    buffer_load_dwordx4 v64, s[32:35], s58 offen offset:0 lds
    ds_read_b64_tr_b16 a[116:117], v125 offset:12288
    ds_read_b64_tr_b16 a[118:119], v125 offset:12800
    buffer_load_dwordx4 v65, s[32:35], s58 offen offset:1024 lds
    ds_read_b64_tr_b16 a[120:121], v126 offset:12288
    ds_read_b64_tr_b16 a[122:123], v126 offset:12800
    buffer_load_dwordx4 v66, s[32:35], s58 offen offset:2048 lds
    ds_read_b64_tr_b16 a[124:125], v127 offset:12288
    ds_read_b64_tr_b16 a[126:127], v127 offset:12800
    buffer_load_dwordx4 v67, s[32:35], s58 offen offset:3072 lds
    s_waitcnt vmcnt(8)
    ds_read_b64_tr_b16 v[0:1], v124 offset:0
    ds_read_b64_tr_b16 v[2:3], v124 offset:512
    s_add_u32 s10, s18, 0
    s_load_dword s10, s[36:37], s10
    s_waitcnt lgkmcnt(2)
    s_add_u32 m0, s65, 12288
    s_lshl_b32 s58, s79, 5
    s_add_u32 s58, s58, s66
    buffer_load_dwordx4 v64, s[32:35], s58 offen offset:0 lds
    ds_read_b64_tr_b16 v[4:5], v125 offset:0
    ds_read_b64_tr_b16 v[6:7], v125 offset:512
    buffer_load_dwordx4 v65, s[32:35], s58 offen offset:1024 lds
    ds_read_b64_tr_b16 v[8:9], v126 offset:0
    ds_read_b64_tr_b16 v[10:11], v126 offset:512
    buffer_load_dwordx4 v66, s[32:35], s58 offen offset:2048 lds
    ds_read_b64_tr_b16 v[12:13], v127 offset:0
    ds_read_b64_tr_b16 v[14:15], v127 offset:512
    buffer_load_dwordx4 v67, s[32:35], s58 offen offset:3072 lds
    s_waitcnt vmcnt(8)
    ds_read_b64_tr_b16 v[16:17], v124 offset:4096
    ds_read_b64_tr_b16 v[18:19], v124 offset:4608
    s_waitcnt lgkmcnt(2)
    s_add_u32 m0, s65, 0
    s_lshl_b32 s58, s80, 5
    s_add_u32 s58, s58, s66
    buffer_load_dwordx4 v64, s[32:35], s58 offen offset:0 lds
    ds_read_b64_tr_b16 v[20:21], v125 offset:4096
    ds_read_b64_tr_b16 v[22:23], v125 offset:4608
    buffer_load_dwordx4 v65, s[32:35], s58 offen offset:1024 lds
    ds_read_b64_tr_b16 v[24:25], v126 offset:4096
    ds_read_b64_tr_b16 v[26:27], v126 offset:4608
    buffer_load_dwordx4 v66, s[32:35], s58 offen offset:2048 lds
    ds_read_b64_tr_b16 v[28:29], v127 offset:4096
    ds_read_b64_tr_b16 v[30:31], v127 offset:4608
    buffer_load_dwordx4 v67, s[32:35], s58 offen offset:3072 lds
    s_branch L_hphase
L_blockA_end:
.p2align 12
L_hphase:
L_pad0:
    s_cbranch_execz L_padend
    s_waitcnt lgkmcnt(0)
    s_cmp_eq_u32 s10, 28
    s_cbranch_scc0 L_st0_retry
L_st0_ok:
    buffer_load_dwordx4 v[80:83], v120, s[36:39], s68 offen sc1
    s_waitcnt vmcnt(9)
    buffer_load_dwordx4 v[84:87], v120, s[36:39], s69 offen sc1
    s_waitcnt vmcnt(9)
    s_add_u32 m0, s65, 4096
    s_lshl_b32 s58, s81, 5
    s_add_u32 s58, s58, s66
    buffer_load_dwordx4 v64, s[32:35], s58 offen offset:0 lds
    s_waitcnt vmcnt(9)
    buffer_load_dwordx4 v[88:91], v120, s[36:39], s70 offen sc1
    s_waitcnt vmcnt(9)
    buffer_load_dwordx4 v[92:95], v120, s[36:39], s78 offen sc1
    s_waitcnt vmcnt(9)
    buffer_load_dwordx4 v65, s[32:35], s58 offen offset:1024 lds
    s_waitcnt vmcnt(9)
    buffer_load_dwordx4 v[96:99], v120, s[36:39], s71 offen sc1
    s_waitcnt vmcnt(9)
    buffer_load_dwordx4 v[100:103], v120, s[36:39], s72 offen sc1
    s_waitcnt vmcnt(9)
    buffer_load_dwordx4 v66, s[32:35], s58 offen offset:2048 lds
    s_waitcnt vmcnt(9)
    buffer_load_dwordx4 v[104:107], v120, s[36:39], s79 offen sc1
    s_add_u32 s10, s18, 4352
    s_load_dword s10, s[36:37], s10
    s_waitcnt vmcnt(9)
    v_mfma_f32_16x16x32_bf16 v[48:51], a[0:3], v[80:83], 0
    ds_read_b64_tr_b16 v[32:33], v124 offset:8192
    v_mfma_f32_16x16x32_bf16 v[52:55], a[4:7], v[80:83], 0
    buffer_load_dwordx4 v[108:111], v120, s[36:39], s73 offen sc1
    ds_read_b64_tr_b16 v[34:35], v124 offset:8704
    v_mfma_f32_16x16x32_bf16 v[56:59], a[8:11], v[80:83], 0
    ds_read_b64_tr_b16 v[36:37], v125 offset:8192
    v_mfma_f32_16x16x32_bf16 v[60:63], a[12:15], v[80:83], 0
    buffer_load_dwordx4 v67, s[32:35], s58 offen offset:3072 lds
    s_waitcnt vmcnt(10)
    v_mfma_f32_16x16x32_bf16 v[48:51], a[16:19], v[84:87], v[48:51]
    ds_read_b64_tr_b16 v[38:39], v125 offset:8704
    v_mfma_f32_16x16x32_bf16 v[52:55], a[20:23], v[84:87], v[52:55]
    buffer_load_dwordx4 v[112:115], v120, s[36:39], s74 offen sc1
    ds_read_b64_tr_b16 v[40:41], v126 offset:8192
    v_mfma_f32_16x16x32_bf16 v[56:59], a[24:27], v[84:87], v[56:59]
    ds_read_b64_tr_b16 v[42:43], v126 offset:8704
    v_mfma_f32_16x16x32_bf16 v[60:63], a[28:31], v[84:87], v[60:63]
    buffer_load_dwordx4 v[116:119], v120, s[36:39], s75 offen sc1
    s_waitcnt vmcnt(10)
    v_mfma_f32_16x16x32_bf16 v[48:51], a[32:35], v[88:91], v[48:51]
    ds_read_b64_tr_b16 v[44:45], v127 offset:8192
    v_mfma_f32_16x16x32_bf16 v[52:55], a[36:39], v[88:91], v[52:55]
    buffer_load_dwordx4 v[80:83], v120, s[36:39], s80 offen sc1
    ds_read_b64_tr_b16 v[46:47], v127 offset:8704
    v_mfma_f32_16x16x32_bf16 v[56:59], a[40:43], v[88:91], v[56:59]
    v_mfma_f32_16x16x32_bf16 v[60:63], a[44:47], v[88:91], v[60:63]
    buffer_load_dwordx4 v[84:87], v120, s[36:39], s76 offen sc1
    s_waitcnt vmcnt(11)
    s_waitcnt lgkmcnt(0)
    s_cmp_eq_u32 s10, 7
    s_cbranch_scc0 L_st1_retry
L_st1_ok:
    v_mfma_f32_16x16x32_bf16 v[48:51], v[32:35], v[92:95], v[48:51]
    ds_read_b64_tr_b16 v[32:33], v124 offset:12288
    v_mfma_f32_16x16x32_bf16 v[52:55], v[36:39], v[92:95], v[52:55]
    buffer_load_dwordx4 v[88:91], v120, s[36:39], s77 offen sc1
    ds_read_b64_tr_b16 v[34:35], v124 offset:12800
    v_mfma_f32_16x16x32_bf16 v[56:59], v[40:43], v[92:95], v[56:59]
    ds_read_b64_tr_b16 v[36:37], v125 offset:12288
    v_mfma_f32_16x16x32_bf16 v[60:63], v[44:47], v[92:95], v[60:63]
    buffer_load_dwordx4 v[92:95], v120, s[36:39], s81 offen sc1
    s_waitcnt vmcnt(11)
    v_mfma_f32_16x16x32_bf16 v[48:51], a[48:51], v[96:99], v[48:51]
    ds_read_b64_tr_b16 v[38:39], v125 offset:12800
    v_mfma_f32_16x16x32_bf16 v[52:55], a[52:55], v[96:99], v[52:55]
    ds_read_b64_tr_b16 v[40:41], v126 offset:12288
    v_mfma_f32_16x16x32_bf16 v[56:59], a[56:59], v[96:99], v[56:59]
    ds_read_b64_tr_b16 v[42:43], v126 offset:12800
    v_mfma_f32_16x16x32_bf16 v[60:63], a[60:63], v[96:99], v[60:63]
    v_add_u32 v120, 229376, v120
    buffer_load_dwordx4 v[96:99], v120, s[36:39], s68 offen sc1
    s_waitcnt vmcnt(11)
    v_mfma_f32_16x16x32_bf16 v[48:51], a[64:67], v[100:103], v[48:51]
    ds_read_b64_tr_b16 v[44:45], v127 offset:12288
    v_mfma_f32_16x16x32_bf16 v[52:55], a[68:71], v[100:103], v[52:55]
    ds_read_b64_tr_b16 v[46:47], v127 offset:12800
    v_mfma_f32_16x16x32_bf16 v[56:59], a[72:75], v[100:103], v[56:59]
    v_mfma_f32_16x16x32_bf16 v[60:63], a[76:79], v[100:103], v[60:63]
    buffer_load_dwordx4 v[100:103], v120, s[36:39], s69 offen sc1
    s_waitcnt vmcnt(10) lgkmcnt(2)
    v_mfma_f32_16x16x32_bf16 v[48:51], v[32:35], v[104:107], v[48:51]
    ds_read_b64_tr_b16 v[32:33], v124 offset:0
    v_mfma_f32_16x16x32_bf16 v[52:55], v[36:39], v[104:107], v[52:55]
    ds_read_b64_tr_b16 v[34:35], v124 offset:512
    v_mfma_f32_16x16x32_bf16 v[56:59], v[40:43], v[104:107], v[56:59]
    ds_read_b64_tr_b16 v[36:37], v125 offset:0
    s_waitcnt lgkmcnt(3)
    v_mfma_f32_16x16x32_bf16 v[60:63], v[44:47], v[104:107], v[60:63]
    buffer_load_dwordx4 v[104:107], v120, s[36:39], s70 offen sc1
    s_waitcnt vmcnt(10)
    v_mfma_f32_16x16x32_bf16 v[48:51], a[80:83], v[108:111], v[48:51]
    ds_read_b64_tr_b16 v[38:39], v125 offset:512
    v_mfma_f32_16x16x32_bf16 v[52:55], a[84:87], v[108:111], v[52:55]
    ds_read_b64_tr_b16 v[40:41], v126 offset:0
    v_mfma_f32_16x16x32_bf16 v[56:59], a[88:91], v[108:111], v[56:59]
    ds_read_b64_tr_b16 v[42:43], v126 offset:512
    v_mfma_f32_16x16x32_bf16 v[60:63], a[92:95], v[108:111], v[60:63]
    buffer_load_dwordx4 v[108:111], v120, s[36:39], s78 offen sc1
    s_waitcnt vmcnt(9)
    v_mfma_f32_16x16x32_bf16 v[48:51], a[96:99], v[112:115], v[48:51]
    ds_read_b64_tr_b16 v[44:45], v127 offset:0
    v_mfma_f32_16x16x32_bf16 v[52:55], a[100:103], v[112:115], v[52:55]
    ds_read_b64_tr_b16 v[46:47], v127 offset:512
    v_mfma_f32_16x16x32_bf16 v[56:59], a[104:107], v[112:115], v[56:59]
    v_mfma_f32_16x16x32_bf16 v[60:63], a[108:111], v[112:115], v[60:63]
    buffer_load_dwordx4 v[112:115], v120, s[36:39], s71 offen sc1
    s_waitcnt vmcnt(9)
    v_mfma_f32_16x16x32_bf16 v[48:51], a[112:115], v[116:119], v[48:51]
    v_mfma_f32_16x16x32_bf16 v[52:55], a[116:119], v[116:119], v[52:55]
    v_mfma_f32_16x16x32_bf16 v[56:59], a[120:123], v[116:119], v[56:59]
    v_mfma_f32_16x16x32_bf16 v[60:63], a[124:127], v[116:119], v[60:63]
    buffer_load_dwordx4 v[116:119], v120, s[36:39], s72 offen sc1
    s_waitcnt vmcnt(9) lgkmcnt(2)
    v_mfma_f32_16x16x32_bf16 v[48:51], v[32:35], v[80:83], v[48:51]
    ds_read_b64_tr_b16 v[32:33], v124 offset:4096
    v_mfma_f32_16x16x32_bf16 v[52:55], v[36:39], v[80:83], v[52:55]
    ds_read_b64_tr_b16 v[34:35], v124 offset:4608
    v_mfma_f32_16x16x32_bf16 v[56:59], v[40:43], v[80:83], v[56:59]
    ds_read_b64_tr_b16 v[36:37], v125 offset:4096
    s_waitcnt lgkmcnt(3)
    v_mfma_f32_16x16x32_bf16 v[60:63], v[44:47], v[80:83], v[60:63]
    buffer_load_dwordx4 v[80:83], v120, s[36:39], s79 offen sc1
    s_waitcnt vmcnt(9)
    v_mfma_f32_16x16x32_bf16 v[48:51], v[0:3], v[84:87], v[48:51]
    ds_read_b64_tr_b16 v[38:39], v125 offset:4608
    v_mfma_f32_16x16x32_bf16 v[52:55], v[4:7], v[84:87], v[52:55]
    ds_read_b64_tr_b16 v[40:41], v126 offset:4096
    v_mfma_f32_16x16x32_bf16 v[56:59], v[8:11], v[84:87], v[56:59]
    ds_read_b64_tr_b16 v[42:43], v126 offset:4608
    v_mfma_f32_16x16x32_bf16 v[60:63], v[12:15], v[84:87], v[60:63]
    buffer_load_dwordx4 v[84:87], v120, s[36:39], s73 offen sc1
    s_add_u32 s10, s18, 8704
    s_load_dword s10, s[36:37], s10
    s_waitcnt vmcnt(9)
    v_mfma_f32_16x16x32_bf16 v[48:51], v[16:19], v[88:91], v[48:51]
    ds_read_b64_tr_b16 v[44:45], v127 offset:4096
    v_mfma_f32_16x16x32_bf16 v[52:55], v[20:23], v[88:91], v[52:55]
    ds_read_b64_tr_b16 v[46:47], v127 offset:4608
    v_mfma_f32_16x16x32_bf16 v[56:59], v[24:27], v[88:91], v[56:59]
    v_mfma_f32_16x16x32_bf16 v[60:63], v[28:31], v[88:91], v[60:63]
    buffer_load_dwordx4 v[88:91], v120, s[36:39], s74 offen sc1
    s_waitcnt vmcnt(9) lgkmcnt(2)
    v_mfma_f32_16x16x32_bf16 v[48:51], v[32:35], v[92:95], v[48:51]
    ds_read_b64_tr_b16 v[32:33], v124 offset:8192
    v_mfma_f32_16x16x32_bf16 v[52:55], v[36:39], v[92:95], v[52:55]
    ds_read_b64_tr_b16 v[34:35], v124 offset:8704
    v_mfma_f32_16x16x32_bf16 v[56:59], v[40:43], v[92:95], v[56:59]
    ds_read_b64_tr_b16 v[36:37], v125 offset:8192
    s_waitcnt lgkmcnt(3)
    v_mfma_f32_16x16x32_bf16 v[60:63], v[44:47], v[92:95], v[60:63]
    buffer_load_dwordx4 v[92:95], v120, s[36:39], s75 offen sc1
    s_waitcnt vmcnt(9)
    v_mfma_f32_16x16x32_bf16 v[64:67], a[0:3], v[96:99], 0
    ds_read_b64_tr_b16 v[38:39], v125 offset:8704
    v_mfma_f32_16x16x32_bf16 v[68:71], a[4:7], v[96:99], 0
    ds_read_b64_tr_b16 v[40:41], v126 offset:8192
    v_mfma_f32_16x16x32_bf16 v[72:75], a[8:11], v[96:99], 0
    ds_read_b64_tr_b16 v[42:43], v126 offset:8704
    v_mfma_f32_16x16x32_bf16 v[76:79], a[12:15], v[96:99], 0
    buffer_load_dwordx4 v[96:99], v120, s[36:39], s80 offen sc1
    s_waitcnt vmcnt(9)
    v_mfma_f32_16x16x32_bf16 v[64:67], a[16:19], v[100:103], v[64:67]
    ds_read_b64_tr_b16 v[44:45], v127 offset:8192
    v_mfma_f32_16x16x32_bf16 v[68:71], a[20:23], v[100:103], v[68:71]
    ds_read_b64_tr_b16 v[46:47], v127 offset:8704
    v_mfma_f32_16x16x32_bf16 v[72:75], a[24:27], v[100:103], v[72:75]
    v_mfma_f32_16x16x32_bf16 v[76:79], a[28:31], v[100:103], v[76:79]
    buffer_load_dwordx4 v[100:103], v120, s[36:39], s76 offen sc1
    s_waitcnt vmcnt(9)
    v_mfma_f32_16x16x32_bf16 v[64:67], a[32:35], v[104:107], v[64:67]
    v_mfma_f32_16x16x32_bf16 v[68:71], a[36:39], v[104:107], v[68:71]
    v_mfma_f32_16x16x32_bf16 v[72:75], a[40:43], v[104:107], v[72:75]
    v_mfma_f32_16x16x32_bf16 v[76:79], a[44:47], v[104:107], v[76:79]
    buffer_load_dwordx4 v[104:107], v120, s[36:39], s77 offen sc1
    s_waitcnt vmcnt(9)
    s_waitcnt lgkmcnt(0)
    s_cmp_eq_u32 s10, 28
    s_cbranch_scc0 L_st2_retry
L_st2_ok:
    v_mfma_f32_16x16x32_bf16 v[64:67], v[32:35], v[108:111], v[64:67]
    ds_read_b64_tr_b16 v[32:33], v124 offset:12288
    v_mfma_f32_16x16x32_bf16 v[68:71], v[36:39], v[108:111], v[68:71]
    ds_read_b64_tr_b16 v[34:35], v124 offset:12800
    v_mfma_f32_16x16x32_bf16 v[72:75], v[40:43], v[108:111], v[72:75]
    ds_read_b64_tr_b16 v[36:37], v125 offset:12288
    v_mfma_f32_16x16x32_bf16 v[76:79], v[44:47], v[108:111], v[76:79]
    buffer_load_dwordx4 v[108:111], v120, s[36:39], s81 offen sc1
    s_waitcnt vmcnt(9)
    v_mfma_f32_16x16x32_bf16 v[64:67], a[48:51], v[112:115], v[64:67]
    ds_read_b64_tr_b16 v[38:39], v125 offset:12800
    v_mfma_f32_16x16x32_bf16 v[68:71], a[52:55], v[112:115], v[68:71]
    ds_read_b64_tr_b16 v[40:41], v126 offset:12288
    v_mfma_f32_16x16x32_bf16 v[72:75], a[56:59], v[112:115], v[72:75]
    ds_read_b64_tr_b16 v[42:43], v126 offset:12800
    v_mfma_f32_16x16x32_bf16 v[76:79], a[60:63], v[112:115], v[76:79]
    v_add_u32 v120, 229376, v120
    buffer_load_dwordx4 v[112:115], v120, s[36:39], s68 offen sc1
    s_waitcnt vmcnt(9)
    v_mfma_f32_16x16x32_bf16 v[64:67], a[64:67], v[116:119], v[64:67]
    ds_read_b64_tr_b16 v[44:45], v127 offset:12288
    v_mfma_f32_16x16x32_bf16 v[68:71], a[68:71], v[116:119], v[68:71]
    ds_read_b64_tr_b16 v[46:47], v127 offset:12800
    v_mfma_f32_16x16x32_bf16 v[72:75], a[72:75], v[116:119], v[72:75]
    ds_write_b128 v123, v[48:51] offset:0
    v_xor_b32 v123, 64, v123
    v_mfma_f32_16x16x32_bf16 v[76:79], a[76:79], v[116:119], v[76:79]
    buffer_load_dwordx4 v[116:119], v120, s[36:39], s69 offen sc1
    s_waitcnt vmcnt(9) lgkmcnt(3)
    v_mfma_f32_16x16x32_bf16 v[64:67], v[32:35], v[80:83], v[64:67]
    ds_read_b64_tr_b16 v[32:33], v124 offset:0
    v_mfma_f32_16x16x32_bf16 v[68:71], v[36:39], v[80:83], v[68:71]
    ds_read_b64_tr_b16 v[34:35], v124 offset:512
    v_mfma_f32_16x16x32_bf16 v[72:75], v[40:43], v[80:83], v[72:75]
    ds_read_b64_tr_b16 v[36:37], v125 offset:0
    s_waitcnt lgkmcnt(4)
    v_mfma_f32_16x16x32_bf16 v[76:79], v[44:47], v[80:83], v[76:79]
    buffer_load_dwordx4 v[80:83], v120, s[36:39], s70 offen sc1
    s_waitcnt vmcnt(9)
    v_mfma_f32_16x16x32_bf16 v[64:67], a[80:83], v[84:87], v[64:67]
    ds_read_b64_tr_b16 v[38:39], v125 offset:512
    v_mfma_f32_16x16x32_bf16 v[68:71], a[84:87], v[84:87], v[68:71]
    ds_read_b64_tr_b16 v[40:41], v126 offset:0
    v_mfma_f32_16x16x32_bf16 v[72:75], a[88:91], v[84:87], v[72:75]
    ds_read_b64_tr_b16 v[42:43], v126 offset:512
    v_mfma_f32_16x16x32_bf16 v[76:79], a[92:95], v[84:87], v[76:79]
    buffer_load_dwordx4 v[84:87], v120, s[36:39], s78 offen sc1
    s_waitcnt vmcnt(9)
    v_mfma_f32_16x16x32_bf16 v[64:67], a[96:99], v[88:91], v[64:67]
    ds_read_b64_tr_b16 v[44:45], v127 offset:0
    v_mfma_f32_16x16x32_bf16 v[68:71], a[100:103], v[88:91], v[68:71]
    ds_read_b64_tr_b16 v[46:47], v127 offset:512
    v_mfma_f32_16x16x32_bf16 v[72:75], a[104:107], v[88:91], v[72:75]
    ds_write_b128 v123, v[52:55] offset:0
    v_xor_b32 v123, 192, v123
    v_mfma_f32_16x16x32_bf16 v[76:79], a[108:111], v[88:91], v[76:79]
    buffer_load_dwordx4 v[88:91], v120, s[36:39], s71 offen sc1
    s_waitcnt vmcnt(9)
    v_mfma_f32_16x16x32_bf16 v[64:67], a[112:115], v[92:95], v[64:67]
    ds_write_b128 v123, v[56:59] offset:0
    v_xor_b32 v123, 64, v123
    v_mfma_f32_16x16x32_bf16 v[68:71], a[116:119], v[92:95], v[68:71]
    ds_write_b128 v123, v[60:63] offset:0
    v_xor_b32 v123, 192, v123
    v_mfma_f32_16x16x32_bf16 v[72:75], a[120:123], v[92:95], v[72:75]
    v_mfma_f32_16x16x32_bf16 v[76:79], a[124:127], v[92:95], v[76:79]
    buffer_load_dwordx4 v[92:95], v120, s[36:39], s72 offen sc1
    s_waitcnt vmcnt(9) lgkmcnt(5)
    v_mfma_f32_16x16x32_bf16 v[64:67], v[32:35], v[96:99], v[64:67]
    ds_read_b64_tr_b16 v[32:33], v124 offset:4096
    v_mfma_f32_16x16x32_bf16 v[68:71], v[36:39], v[96:99], v[68:71]
    ds_read_b64_tr_b16 v[34:35], v124 offset:4608
    v_mfma_f32_16x16x32_bf16 v[72:75], v[40:43], v[96:99], v[72:75]
    ds_read_b64_tr_b16 v[36:37], v125 offset:4096
    s_waitcnt lgkmcnt(6)
    v_mfma_f32_16x16x32_bf16 v[76:79], v[44:47], v[96:99], v[76:79]
    buffer_load_dwordx4 v[96:99], v120, s[36:39], s79 offen sc1
    s_waitcnt vmcnt(9)
    v_mfma_f32_16x16x32_bf16 v[64:67], v[0:3], v[100:103], v[64:67]
    ds_read_b64_tr_b16 v[38:39], v125 offset:4608
    v_mfma_f32_16x16x32_bf16 v[68:71], v[4:7], v[100:103], v[68:71]
    ds_read_b64_tr_b16 v[40:41], v126 offset:4096
    v_mfma_f32_16x16x32_bf16 v[72:75], v[8:11], v[100:103], v[72:75]
    ds_read_b64_tr_b16 v[42:43], v126 offset:4608
    v_mfma_f32_16x16x32_bf16 v[76:79], v[12:15], v[100:103], v[76:79]
    buffer_load_dwordx4 v[100:103], v120, s[36:39], s73 offen sc1
    s_add_u32 s10, s18, 13056
    s_load_dword s10, s[36:37], s10
    s_waitcnt vmcnt(9)
    v_mfma_f32_16x16x32_bf16 v[64:67], v[16:19], v[104:107], v[64:67]
    ds_read_b64_tr_b16 v[44:45], v127 offset:4096
    v_mfma_f32_16x16x32_bf16 v[68:71], v[20:23], v[104:107], v[68:71]
    ds_read_b64_tr_b16 v[46:47], v127 offset:4608
    v_mfma_f32_16x16x32_bf16 v[72:75], v[24:27], v[104:107], v[72:75]
    v_mfma_f32_16x16x32_bf16 v[76:79], v[28:31], v[104:107], v[76:79]
    buffer_load_dwordx4 v[104:107], v120, s[36:39], s74 offen sc1
    s_waitcnt vmcnt(9) lgkmcnt(2)
    v_mfma_f32_16x16x32_bf16 v[64:67], v[32:35], v[108:111], v[64:67]
    ds_read_b64_tr_b16 v[32:33], v124 offset:8192
    v_mfma_f32_16x16x32_bf16 v[68:71], v[36:39], v[108:111], v[68:71]
    ds_read_b64_tr_b16 v[34:35], v124 offset:8704
    v_mfma_f32_16x16x32_bf16 v[72:75], v[40:43], v[108:111], v[72:75]
    ds_read_b64_tr_b16 v[36:37], v125 offset:8192
    s_waitcnt lgkmcnt(3)
    v_mfma_f32_16x16x32_bf16 v[76:79], v[44:47], v[108:111], v[76:79]
    buffer_load_dwordx4 v[108:111], v120, s[36:39], s75 offen sc1
    s_waitcnt vmcnt(9)
    v_mfma_f32_16x16x32_bf16 v[48:51], a[0:3], v[112:115], 0
    ds_read_b64_tr_b16 v[38:39], v125 offset:8704
    v_mfma_f32_16x16x32_bf16 v[52:55], a[4:7], v[112:115], 0
    ds_read_b64_tr_b16 v[40:41], v126 offset:8192
    v_mfma_f32_16x16x32_bf16 v[56:59], a[8:11], v[112:115], 0
    ds_read_b64_tr_b16 v[42:43], v126 offset:8704
    v_mfma_f32_16x16x32_bf16 v[60:63], a[12:15], v[112:115], 0
    buffer_load_dwordx4 v[112:115], v120, s[36:39], s80 offen sc1
    s_waitcnt vmcnt(9)
    v_mfma_f32_16x16x32_bf16 v[48:51], a[16:19], v[116:119], v[48:51]
    ds_read_b64_tr_b16 v[44:45], v127 offset:8192
    v_mfma_f32_16x16x32_bf16 v[52:55], a[20:23], v[116:119], v[52:55]
    ds_read_b64_tr_b16 v[46:47], v127 offset:8704
    v_mfma_f32_16x16x32_bf16 v[56:59], a[24:27], v[116:119], v[56:59]
    v_mfma_f32_16x16x32_bf16 v[60:63], a[28:31], v[116:119], v[60:63]
    buffer_load_dwordx4 v[116:119], v120, s[36:39], s76 offen sc1
    s_waitcnt vmcnt(9)
    v_mfma_f32_16x16x32_bf16 v[48:51], a[32:35], v[80:83], v[48:51]
    v_mfma_f32_16x16x32_bf16 v[52:55], a[36:39], v[80:83], v[52:55]
    v_mfma_f32_16x16x32_bf16 v[56:59], a[40:43], v[80:83], v[56:59]
    v_mfma_f32_16x16x32_bf16 v[60:63], a[44:47], v[80:83], v[60:63]
    buffer_load_dwordx4 v[80:83], v120, s[36:39], s77 offen sc1
    s_waitcnt vmcnt(9)
    s_waitcnt lgkmcnt(0)
    s_cmp_eq_u32 s10, 28
    s_cbranch_scc0 L_st3_retry
L_st3_ok:
    v_mfma_f32_16x16x32_bf16 v[48:51], v[32:35], v[84:87], v[48:51]
    ds_read_b64_tr_b16 v[32:33], v124 offset:12288
    v_mfma_f32_16x16x32_bf16 v[52:55], v[36:39], v[84:87], v[52:55]
    ds_read_b64_tr_b16 v[34:35], v124 offset:12800
    v_mfma_f32_16x16x32_bf16 v[56:59], v[40:43], v[84:87], v[56:59]
    ds_read_b64_tr_b16 v[36:37], v125 offset:12288
    v_mfma_f32_16x16x32_bf16 v[60:63], v[44:47], v[84:87], v[60:63]
    buffer_load_dwordx4 v[84:87], v120, s[36:39], s81 offen sc1
    s_waitcnt vmcnt(9)
    v_mfma_f32_16x16x32_bf16 v[48:51], a[48:51], v[88:91], v[48:51]
    ds_read_b64_tr_b16 v[38:39], v125 offset:12800
    v_mfma_f32_16x16x32_bf16 v[52:55], a[52:55], v[88:91], v[52:55]
    ds_read_b64_tr_b16 v[40:41], v126 offset:12288
    v_mfma_f32_16x16x32_bf16 v[56:59], a[56:59], v[88:91], v[56:59]
    ds_read_b64_tr_b16 v[42:43], v126 offset:12800
    v_mfma_f32_16x16x32_bf16 v[60:63], a[60:63], v[88:91], v[60:63]
    v_add_u32 v120, 229376, v120
    buffer_load_dwordx4 v[88:91], v120, s[36:39], s68 offen sc1
    s_waitcnt vmcnt(9)
    v_mfma_f32_16x16x32_bf16 v[48:51], a[64:67], v[92:95], v[48:51]
    ds_read_b64_tr_b16 v[44:45], v127 offset:12288
    v_mfma_f32_16x16x32_bf16 v[52:55], a[68:71], v[92:95], v[52:55]
    ds_read_b64_tr_b16 v[46:47], v127 offset:12800
    v_mfma_f32_16x16x32_bf16 v[56:59], a[72:75], v[92:95], v[56:59]
    ds_write_b128 v123, v[64:67] offset:16384
    v_xor_b32 v123, 64, v123
    v_mfma_f32_16x16x32_bf16 v[60:63], a[76:79], v[92:95], v[60:63]
    buffer_load_dwordx4 v[92:95], v120, s[36:39], s69 offen sc1
    s_waitcnt vmcnt(9) lgkmcnt(3)
    v_mfma_f32_16x16x32_bf16 v[48:51], v[32:35], v[96:99], v[48:51]
    ds_read_b64_tr_b16 v[32:33], v124 offset:0
    v_mfma_f32_16x16x32_bf16 v[52:55], v[36:39], v[96:99], v[52:55]
    ds_read_b64_tr_b16 v[34:35], v124 offset:512
    v_mfma_f32_16x16x32_bf16 v[56:59], v[40:43], v[96:99], v[56:59]
    ds_read_b64_tr_b16 v[36:37], v125 offset:0
    s_waitcnt lgkmcnt(4)
    v_mfma_f32_16x16x32_bf16 v[60:63], v[44:47], v[96:99], v[60:63]
    buffer_load_dwordx4 v[96:99], v120, s[36:39], s70 offen sc1
    s_waitcnt vmcnt(9)
    v_mfma_f32_16x16x32_bf16 v[48:51], a[80:83], v[100:103], v[48:51]
    ds_read_b64_tr_b16 v[38:39], v125 offset:512
    v_mfma_f32_16x16x32_bf16 v[52:55], a[84:87], v[100:103], v[52:55]
    ds_read_b64_tr_b16 v[40:41], v126 offset:0
    v_mfma_f32_16x16x32_bf16 v[56:59], a[88:91], v[100:103], v[56:59]
    ds_read_b64_tr_b16 v[42:43], v126 offset:512
    v_mfma_f32_16x16x32_bf16 v[60:63], a[92:95], v[100:103], v[60:63]
    buffer_load_dwordx4 v[100:103], v120, s[36:39], s78 offen sc1
    s_waitcnt vmcnt(9)
    v_mfma_f32_16x16x32_bf16 v[48:51], a[96:99], v[104:107], v[48:51]
    ds_read_b64_tr_b16 v[44:45], v127 offset:0
    v_mfma_f32_16x16x32_bf16 v[52:55], a[100:103], v[104:107], v[52:55]
    ds_read_b64_tr_b16 v[46:47], v127 offset:512
    v_mfma_f32_16x16x32_bf16 v[56:59], a[104:107], v[104:107], v[56:59]
    ds_write_b128 v123, v[68:71] offset:16384
    v_xor_b32 v123, 192, v123
    v_mfma_f32_16x16x32_bf16 v[60:63], a[108:111], v[104:107], v[60:63]
    buffer_load_dwordx4 v[104:107], v120, s[36:39], s71 offen sc1
    s_waitcnt vmcnt(9)
    v_mfma_f32_16x16x32_bf16 v[48:51], a[112:115], v[108:111], v[48:51]
    ds_write_b128 v123, v[72:75] offset:16384
    v_xor_b32 v123, 64, v123
    v_mfma_f32_16x16x32_bf16 v[52:55], a[116:119], v[108:111], v[52:55]
    ds_write_b128 v123, v[76:79] offset:16384
    v_xor_b32 v123, 192, v123
    v_mfma_f32_16x16x32_bf16 v[56:59], a[120:123], v[108:111], v[56:59]
    v_mfma_f32_16x16x32_bf16 v[60:63], a[124:127], v[108:111], v[60:63]
    buffer_load_dwordx4 v[108:111], v120, s[36:39], s72 offen sc1
    s_waitcnt vmcnt(9) lgkmcnt(5)
    v_mfma_f32_16x16x32_bf16 v[48:51], v[32:35], v[112:115], v[48:51]
    ds_read_b64_tr_b16 v[32:33], v124 offset:4096
    v_mfma_f32_16x16x32_bf16 v[52:55], v[36:39], v[112:115], v[52:55]
    ds_read_b64_tr_b16 v[34:35], v124 offset:4608
    v_mfma_f32_16x16x32_bf16 v[56:59], v[40:43], v[112:115], v[56:59]
    ds_read_b64_tr_b16 v[36:37], v125 offset:4096
    s_waitcnt lgkmcnt(6)
    v_mfma_f32_16x16x32_bf16 v[60:63], v[44:47], v[112:115], v[60:63]
    buffer_load_dwordx4 v[112:115], v120, s[36:39], s79 offen sc1
    s_waitcnt vmcnt(9)
    v_mfma_f32_16x16x32_bf16 v[48:51], v[0:3], v[116:119], v[48:51]
    ds_read_b64_tr_b16 v[38:39], v125 offset:4608
    v_mfma_f32_16x16x32_bf16 v[52:55], v[4:7], v[116:119], v[52:55]
    ds_read_b64_tr_b16 v[40:41], v126 offset:4096
    v_mfma_f32_16x16x32_bf16 v[56:59], v[8:11], v[116:119], v[56:59]
    ds_read_b64_tr_b16 v[42:43], v126 offset:4608
    v_mfma_f32_16x16x32_bf16 v[60:63], v[12:15], v[116:119], v[60:63]
    buffer_load_dwordx4 v[116:119], v120, s[36:39], s73 offen sc1
    s_waitcnt vmcnt(9)
    v_mfma_f32_16x16x32_bf16 v[48:51], v[16:19], v[80:83], v[48:51]
    ds_read_b64_tr_b16 v[44:45], v127 offset:4096
    v_mfma_f32_16x16x32_bf16 v[52:55], v[20:23], v[80:83], v[52:55]
    ds_read_b64_tr_b16 v[46:47], v127 offset:4608
    v_mfma_f32_16x16x32_bf16 v[56:59], v[24:27], v[80:83], v[56:59]
    v_mfma_f32_16x16x32_bf16 v[60:63], v[28:31], v[80:83], v[60:63]
    buffer_load_dwordx4 v[80:83], v120, s[36:39], s74 offen sc1
    s_waitcnt vmcnt(9) lgkmcnt(2)
    v_mfma_f32_16x16x32_bf16 v[48:51], v[32:35], v[84:87], v[48:51]
    ds_read_b64_tr_b16 v[32:33], v124 offset:8192
    v_mfma_f32_16x16x32_bf16 v[52:55], v[36:39], v[84:87], v[52:55]
    ds_read_b64_tr_b16 v[34:35], v124 offset:8704
    v_mfma_f32_16x16x32_bf16 v[56:59], v[40:43], v[84:87], v[56:59]
    ds_read_b64_tr_b16 v[36:37], v125 offset:8192
    s_waitcnt lgkmcnt(3)
    v_mfma_f32_16x16x32_bf16 v[60:63], v[44:47], v[84:87], v[60:63]
    buffer_load_dwordx4 v[84:87], v120, s[36:39], s75 offen sc1
    s_waitcnt vmcnt(9)
    v_mfma_f32_16x16x32_bf16 v[64:67], a[0:3], v[88:91], 0
    ds_read_b64_tr_b16 v[38:39], v125 offset:8704
    v_mfma_f32_16x16x32_bf16 v[68:71], a[4:7], v[88:91], 0
    ds_read_b64_tr_b16 v[40:41], v126 offset:8192
    v_mfma_f32_16x16x32_bf16 v[72:75], a[8:11], v[88:91], 0
    ds_read_b64_tr_b16 v[42:43], v126 offset:8704
    v_mfma_f32_16x16x32_bf16 v[76:79], a[12:15], v[88:91], 0
    buffer_load_dwordx4 v[88:91], v120, s[36:39], s80 offen sc1
    s_waitcnt vmcnt(9)
    v_mfma_f32_16x16x32_bf16 v[64:67], a[16:19], v[92:95], v[64:67]
    ds_read_b64_tr_b16 v[44:45], v127 offset:8192
    v_mfma_f32_16x16x32_bf16 v[68:71], a[20:23], v[92:95], v[68:71]
    ds_read_b64_tr_b16 v[46:47], v127 offset:8704
    v_mfma_f32_16x16x32_bf16 v[72:75], a[24:27], v[92:95], v[72:75]
    ds_write_b128 v123, v[48:51] offset:32768
    v_xor_b32 v123, 64, v123
    v_mfma_f32_16x16x32_bf16 v[76:79], a[28:31], v[92:95], v[76:79]
    buffer_load_dwordx4 v[92:95], v120, s[36:39], s76 offen sc1
    s_waitcnt vmcnt(9)
    v_mfma_f32_16x16x32_bf16 v[64:67], a[32:35], v[96:99], v[64:67]
    ds_write_b128 v123, v[52:55] offset:32768
    v_xor_b32 v123, 192, v123
    v_mfma_f32_16x16x32_bf16 v[68:71], a[36:39], v[96:99], v[68:71]
    ds_write_b128 v123, v[56:59] offset:32768
    v_xor_b32 v123, 64, v123
    v_mfma_f32_16x16x32_bf16 v[72:75], a[40:43], v[96:99], v[72:75]
    ds_write_b128 v123, v[60:63] offset:32768
    v_xor_b32 v123, 192, v123
    v_mfma_f32_16x16x32_bf16 v[76:79], a[44:47], v[96:99], v[76:79]
    buffer_load_dwordx4 v[96:99], v120, s[36:39], s77 offen sc1
    s_waitcnt vmcnt(9) lgkmcnt(6)
    v_mfma_f32_16x16x32_bf16 v[64:67], v[32:35], v[100:103], v[64:67]
    ds_read_b64_tr_b16 v[32:33], v124 offset:12288
    v_mfma_f32_16x16x32_bf16 v[68:71], v[36:39], v[100:103], v[68:71]
    ds_read_b64_tr_b16 v[34:35], v124 offset:12800
    v_mfma_f32_16x16x32_bf16 v[72:75], v[40:43], v[100:103], v[72:75]
    ds_read_b64_tr_b16 v[36:37], v125 offset:12288
    s_waitcnt lgkmcnt(7)
    v_mfma_f32_16x16x32_bf16 v[76:79], v[44:47], v[100:103], v[76:79]
    buffer_load_dwordx4 v[100:103], v120, s[36:39], s81 offen sc1
    s_waitcnt vmcnt(9)
    v_mfma_f32_16x16x32_bf16 v[64:67], a[48:51], v[104:107], v[64:67]
    ds_read_b64_tr_b16 v[38:39], v125 offset:12800
    v_mfma_f32_16x16x32_bf16 v[68:71], a[52:55], v[104:107], v[68:71]
    ds_read_b64_tr_b16 v[40:41], v126 offset:12288
    v_mfma_f32_16x16x32_bf16 v[72:75], a[56:59], v[104:107], v[72:75]
    ds_read_b64_tr_b16 v[42:43], v126 offset:12800
    v_mfma_f32_16x16x32_bf16 v[76:79], a[60:63], v[104:107], v[76:79]
    ds_read_b64_tr_b16 v[44:45], v127 offset:12288
    s_waitcnt lgkmcnt(7)
    s_barrier
    s_waitcnt vmcnt(8)
    v_mfma_f32_16x16x32_bf16 v[64:67], a[64:67], v[108:111], v[64:67]
    ds_read_b64_tr_b16 v[46:47], v127 offset:12800
    v_mfma_f32_16x16x32_bf16 v[68:71], a[68:71], v[108:111], v[68:71]
    v_mfma_f32_16x16x32_bf16 v[72:75], a[72:75], v[108:111], v[72:75]
    v_mfma_f32_16x16x32_bf16 v[76:79], a[76:79], v[108:111], v[76:79]
    s_waitcnt vmcnt(7) lgkmcnt(2)
    v_mfma_f32_16x16x32_bf16 v[64:67], v[32:35], v[112:115], v[64:67]
    ds_read_b64_tr_b16 v[32:33], v124 offset:0
    v_mfma_f32_16x16x32_bf16 v[68:71], v[36:39], v[112:115], v[68:71]
    ds_read_b64_tr_b16 v[34:35], v124 offset:512
    v_mfma_f32_16x16x32_bf16 v[72:75], v[40:43], v[112:115], v[72:75]
    ds_read_b64_tr_b16 v[36:37], v125 offset:0
    s_waitcnt lgkmcnt(3)
    v_mfma_f32_16x16x32_bf16 v[76:79], v[44:47], v[112:115], v[76:79]
    ds_read_b64_tr_b16 v[38:39], v125 offset:512
    s_waitcnt vmcnt(6)
    v_mfma_f32_16x16x32_bf16 v[64:67], a[80:83], v[116:119], v[64:67]
    ds_read_b64_tr_b16 v[40:41], v126 offset:0
    v_mfma_f32_16x16x32_bf16 v[68:71], a[84:87], v[116:119], v[68:71]
    ds_read_b64_tr_b16 v[42:43], v126 offset:512
    v_mfma_f32_16x16x32_bf16 v[72:75], a[88:91], v[116:119], v[72:75]
    ds_read_b64_tr_b16 v[44:45], v127 offset:0
    v_mfma_f32_16x16x32_bf16 v[76:79], a[92:95], v[116:119], v[76:79]
    ds_read_b64_tr_b16 v[46:47], v127 offset:512
    s_waitcnt vmcnt(5)
    v_mfma_f32_16x16x32_bf16 v[64:67], a[96:99], v[80:83], v[64:67]
    v_mfma_f32_16x16x32_bf16 v[68:71], a[100:103], v[80:83], v[68:71]
    v_mfma_f32_16x16x32_bf16 v[72:75], a[104:107], v[80:83], v[72:75]
    v_mfma_f32_16x16x32_bf16 v[76:79], a[108:111], v[80:83], v[76:79]
    s_waitcnt vmcnt(4)
    v_mfma_f32_16x16x32_bf16 v[64:67], a[112:115], v[84:87], v[64:67]
    v_mfma_f32_16x16x32_bf16 v[68:71], a[116:119], v[84:87], v[68:71]
    v_mfma_f32_16x16x32_bf16 v[72:75], a[120:123], v[84:87], v[72:75]
    v_mfma_f32_16x16x32_bf16 v[76:79], a[124:127], v[84:87], v[76:79]
    s_waitcnt vmcnt(3) lgkmcnt(2)
    v_mfma_f32_16x16x32_bf16 v[64:67], v[32:35], v[88:91], v[64:67]
    ds_read_b64_tr_b16 v[32:33], v124 offset:4096
    v_mfma_f32_16x16x32_bf16 v[68:71], v[36:39], v[88:91], v[68:71]
    ds_read_b64_tr_b16 v[34:35], v124 offset:4608
    v_mfma_f32_16x16x32_bf16 v[72:75], v[40:43], v[88:91], v[72:75]
    ds_read_b64_tr_b16 v[36:37], v125 offset:4096
    s_waitcnt lgkmcnt(3)
    v_mfma_f32_16x16x32_bf16 v[76:79], v[44:47], v[88:91], v[76:79]
    ds_read_b64_tr_b16 v[38:39], v125 offset:4608
    s_waitcnt vmcnt(2)
    v_mfma_f32_16x16x32_bf16 v[64:67], v[0:3], v[92:95], v[64:67]
    ds_read_b64_tr_b16 v[40:41], v126 offset:4096
    s_waitcnt vmcnt(1)
    v_mfma_f32_16x16x32_bf16 v[64:67], v[16:19], v[96:99], v[64:67]
    ds_read_b64_tr_b16 v[42:43], v126 offset:4608
    s_waitcnt vmcnt(0) lgkmcnt(4)
    v_mfma_f32_16x16x32_bf16 v[64:67], v[32:35], v[100:103], v[64:67]
    ds_read_b64_tr_b16 v[44:45], v127 offset:4096
    v_mfma_f32_16x16x32_bf16 v[68:71], v[4:7], v[92:95], v[68:71]
    ds_read_b64_tr_b16 v[46:47], v127 offset:4608
    s_nop 0
    v_mfma_f32_16x16x32_bf16 v[68:71], v[20:23], v[96:99], v[68:71]
    s_nop 1
    s_waitcnt lgkmcnt(4)
    v_mfma_f32_16x16x32_bf16 v[68:71], v[36:39], v[100:103], v[68:71]
    s_nop 0
    ds_write_b128 v123, v[64:67] offset:49152
    v_xor_b32 v123, 64, v123
    v_mfma_f32_16x16x32_bf16 v[72:75], v[8:11], v[92:95], v[72:75]
    s_nop 1
    v_mfma_f32_16x16x32_bf16 v[72:75], v[24:27], v[96:99], v[72:75]
    s_nop 1
    s_waitcnt lgkmcnt(3)
    v_mfma_f32_16x16x32_bf16 v[72:75], v[40:43], v[100:103], v[72:75]
    s_nop 0
    ds_write_b128 v123, v[68:71] offset:49152
    v_xor_b32 v123, 192, v123
    v_mfma_f32_16x16x32_bf16 v[76:79], v[12:15], v[92:95], v[76:79]
    s_nop 1
    v_mfma_f32_16x16x32_bf16 v[76:79], v[28:31], v[96:99], v[76:79]
    s_nop 1
    s_waitcnt lgkmcnt(2)
    v_mfma_f32_16x16x32_bf16 v[76:79], v[44:47], v[100:103], v[76:79]
    s_nop 0
    ds_write_b128 v123, v[72:75] offset:49152
    v_xor_b32 v123, 64, v123
    s_nop 4
    ds_write_b128 v123, v[76:79] offset:49152
    s_waitcnt lgkmcnt(0)
    s_barrier
    s_endpgm
L_rdy_retry:
    s_mov_b32 s61, 65536
L_rdy_loop:
    s_sub_u32 s61, s61, 1
    s_cbranch_scc1 L_rdy_ok
    v_mov_b32 v122, 0
    buffer_load_dword v122, v122, s[44:47], 0 offen sc1
    s_waitcnt vmcnt(0)
    v_cmp_ne_u32 vcc, 1, v122
    s_cbranch_vccz L_rdy_ok
    s_sleep 2
    s_branch L_rdy_loop
L_st0_retry:
    s_mov_b32 s61, 65536
L_st0_loop:
    s_sub_u32 s61, s61, 1
    s_cbranch_scc1 L_st0_ok
    s_add_u32 s10, s18, 0
    buffer_load_dword v122, off, s[36:39], s10 sc1
    s_waitcnt vmcnt(0)
    v_cmp_ne_u32 vcc, 28, v122
    s_cbranch_vccz L_st0_ok
    s_sleep 2
    s_branch L_st0_loop
L_st1_retry:
    s_mov_b32 s61, 65536
L_st1_loop:
    s_sub_u32 s61, s61, 1
    s_cbranch_scc1 L_st1_ok
    s_add_u32 s10, s18, 4352
    buffer_load_dword v122, off, s[36:39], s10 sc1
    s_waitcnt vmcnt(0)
    v_cmp_ne_u32 vcc, 7, v122
    s_cbranch_vccz L_st1_ok
    s_sleep 2
    s_branch L_st1_loop
L_st2_retry:
    s_mov_b32 s61, 65536
L_st2_loop:
    s_sub_u32 s61, s61, 1
    s_cbranch_scc1 L_st2_ok
    s_add_u32 s10, s18, 8704
    buffer_load_dword v122, off, s[36:39], s10 sc1
    s_waitcnt vmcnt(0)
    v_cmp_ne_u32 vcc, 28, v122
    s_cbranch_vccz L_st2_ok
    s_sleep 2
    s_branch L_st2_loop
L_st3_retry:
    s_mov_b32 s61, 65536
L_st3_loop:
    s_sub_u32 s61, s61, 1
    s_cbranch_scc1 L_st3_ok
    s_add_u32 s10, s18, 13056
    buffer_load_dword v122, off, s[36:39], s10 sc1
    s_waitcnt vmcnt(0)
    v_cmp_ne_u32 vcc, 28, v122
    s_cbranch_vccz L_st3_ok
    s_sleep 2
    s_branch L_st3_loop
L_loader_idle:
    s_barrier
    s_add_u32 m0, s65, 0
    s_lshl_b32 s58, s68, 5
    s_add_u32 s58, s58, s66
    buffer_load_dwordx4 v64, s[32:35], s58 offen offset:0 lds
    buffer_load_dwordx4 v65, s[32:35], s58 offen offset:1024 lds
    buffer_load_dwordx4 v66, s[32:35], s58 offen offset:2048 lds
    buffer_load_dwordx4 v67, s[32:35], s58 offen offset:3072 lds
    s_add_u32 m0, s65, 4096
    s_lshl_b32 s58, s69, 5
    s_add_u32 s58, s58, s66
    buffer_load_dwordx4 v64, s[32:35], s58 offen offset:0 lds
    buffer_load_dwordx4 v65, s[32:35], s58 offen offset:1024 lds
    buffer_load_dwordx4 v66, s[32:35], s58 offen offset:2048 lds
    buffer_load_dwordx4 v67, s[32:35], s58 offen offset:3072 lds
    s_add_u32 m0, s65, 8192
    s_lshl_b32 s58, s70, 5
    s_add_u32 s58, s58, s66
    buffer_load_dwordx4 v64, s[32:35], s58 offen offset:0 lds
    buffer_load_dwordx4 v65, s[32:35], s58 offen offset:1024 lds
    buffer_load_dwordx4 v66, s[32:35], s58 offen offset:2048 lds
    buffer_load_dwordx4 v67, s[32:35], s58 offen offset:3072 lds
    s_waitcnt vmcnt(8)
    ds_read_b64_tr_b16 a[0:1], v124 offset:0
    ds_read_b64_tr_b16 a[2:3], v124 offset:512
    s_add_u32 m0, s65, 12288
    s_lshl_b32 s58, s71, 5
    s_add_u32 s58, s58, s66
    buffer_load_dwordx4 v64, s[32:35], s58 offen offset:0 lds
    ds_read_b64_tr_b16 a[4:5], v125 offset:0
    ds_read_b64_tr_b16 a[6:7], v125 offset:512
    buffer_load_dwordx4 v65, s[32:35], s58 offen offset:1024 lds
    ds_read_b64_tr_b16 a[8:9], v126 offset:0
    ds_read_b64_tr_b16 a[10:11], v126 offset:512
    buffer_load_dwordx4 v66, s[32:35], s58 offen offset:2048 lds
    ds_read_b64_tr_b16 a[12:13], v127 offset:0
    ds_read_b64_tr_b16 a[14:15], v127 offset:512
    buffer_load_dwordx4 v67, s[32:35], s58 offen offset:3072 lds
    s_waitcnt vmcnt(8)
    ds_read_b64_tr_b16 a[16:17], v124 offset:4096
    ds_read_b64_tr_b16 a[18:19], v124 offset:4608
    s_waitcnt lgkmcnt(2)
    s_add_u32 m0, s65, 0
    s_lshl_b32 s58, s72, 5
    s_add_u32 s58, s58, s66
    buffer_load_dwordx4 v64, s[32:35], s58 offen offset:0 lds
    ds_read_b64_tr_b16 a[20:21], v125 offset:4096
    ds_read_b64_tr_b16 a[22:23], v125 offset:4608
    buffer_load_dwordx4 v65, s[32:35], s58 offen offset:1024 lds
    ds_read_b64_tr_b16 a[24:25], v126 offset:4096
    ds_read_b64_tr_b16 a[26:27], v126 offset:4608
    buffer_load_dwordx4 v66, s[32:35], s58 offen offset:2048 lds
    ds_read_b64_tr_b16 a[28:29], v127 offset:4096
    ds_read_b64_tr_b16 a[30:31], v127 offset:4608
    buffer_load_dwordx4 v67, s[32:35], s58 offen offset:3072 lds
    s_waitcnt vmcnt(8)
    ds_read_b64_tr_b16 a[32:33], v124 offset:8192
    ds_read_b64_tr_b16 a[34:35], v124 offset:8704
    s_waitcnt lgkmcnt(2)
    s_add_u32 m0, s65, 4096
    s_lshl_b32 s58, s73, 5
    s_add_u32 s58, s58, s66
    buffer_load_dwordx4 v64, s[32:35], s58 offen offset:0 lds
    ds_read_b64_tr_b16 a[36:37], v125 offset:8192
    ds_read_b64_tr_b16 a[38:39], v125 offset:8704
    buffer_load_dwordx4 v65, s[32:35], s58 offen offset:1024 lds
    ds_read_b64_tr_b16 a[40:41], v126 offset:8192
    ds_read_b64_tr_b16 a[42:43], v126 offset:8704
    buffer_load_dwordx4 v66, s[32:35], s58 offen offset:2048 lds
    ds_read_b64_tr_b16 a[44:45], v127 offset:8192
    ds_read_b64_tr_b16 a[46:47], v127 offset:8704
    buffer_load_dwordx4 v67, s[32:35], s58 offen offset:3072 lds
    s_waitcnt vmcnt(8)
    ds_read_b64_tr_b16 a[48:49], v124 offset:12288
    ds_read_b64_tr_b16 a[50:51], v124 offset:12800
    s_waitcnt lgkmcnt(2)
    s_add_u32 m0, s65, 8192
    s_lshl_b32 s58, s74, 5
    s_add_u32 s58, s58, s66
    buffer_load_dwordx4 v64, s[32:35], s58 offen offset:0 lds
    ds_read_b64_tr_b16 a[52:53], v125 offset:12288
    ds_read_b64_tr_b16 a[54:55], v125 offset:12800
    buffer_load_dwordx4 v65, s[32:35], s58 offen offset:1024 lds
    ds_read_b64_tr_b16 a[56:57], v126 offset:12288
    ds_read_b64_tr_b16 a[58:59], v126 offset:12800
    buffer_load_dwordx4 v66, s[32:35], s58 offen offset:2048 lds
    ds_read_b64_tr_b16 a[60:61], v127 offset:12288
    ds_read_b64_tr_b16 a[62:63], v127 offset:12800
    buffer_load_dwordx4 v67, s[32:35], s58 offen offset:3072 lds
    s_waitcnt vmcnt(8)
    ds_read_b64_tr_b16 a[64:65], v124 offset:0
    ds_read_b64_tr_b16 a[66:67], v124 offset:512
    s_waitcnt lgkmcnt(2)
    s_add_u32 m0, s65, 12288
    s_lshl_b32 s58, s75, 5
    s_add_u32 s58, s58, s66
    buffer_load_dwordx4 v64, s[32:35], s58 offen offset:0 lds
    ds_read_b64_tr_b16 a[68:69], v125 offset:0
    ds_read_b64_tr_b16 a[70:71], v125 offset:512
    buffer_load_dwordx4 v65, s[32:35], s58 offen offset:1024 lds
    ds_read_b64_tr_b16 a[72:73], v126 offset:0
    ds_read_b64_tr_b16 a[74:75], v126 offset:512
    buffer_load_dwordx4 v66, s[32:35], s58 offen offset:2048 lds
    ds_read_b64_tr_b16 a[76:77], v127 offset:0
    ds_read_b64_tr_b16 a[78:79], v127 offset:512
    buffer_load_dwordx4 v67, s[32:35], s58 offen offset:3072 lds
    s_waitcnt vmcnt(8)
    ds_read_b64_tr_b16 a[80:81], v124 offset:4096
    ds_read_b64_tr_b16 a[82:83], v124 offset:4608
    s_waitcnt lgkmcnt(2)
    s_add_u32 m0, s65, 0
    s_lshl_b32 s58, s76, 5
    s_add_u32 s58, s58, s66
    buffer_load_dwordx4 v64, s[32:35], s58 offen offset:0 lds
    ds_read_b64_tr_b16 a[84:85], v125 offset:4096
    ds_read_b64_tr_b16 a[86:87], v125 offset:4608
    s_waitcnt vmcnt(9) lgkmcnt(0)
    s_branch L_loader_join
.p2align 12
L_p1:
    s_mov_b64 exec, -1
    s_setprio 2
    s_load_dwordx2 s[32:33], s[0:1], 24
    s_load_dwordx2 s[40:41], s[0:1], 32
    s_load_dwordx2 s[44:45], s[0:1], 40
    s_load_dwordx2 s[36:37], s[0:1], 48
    s_mov_b32 s34, 1835008
    s_mov_b32 s35, 0x20000
    s_mov_b32 s38, 268435456
    s_mov_b32 s39, 0x20000
    s_mov_b32 s42, 2097152
    s_mov_b32 s43, 0x20000
    s_mov_b32 s46, 256
    s_mov_b32 s47, 0x20000
    s_lshr_b32 s55, s49, 2
    s_and_b32 s54, s52, 3
    s_cmp_lt_u32 s55, 4
    s_cselect_b32 s55, s54, s55
    s_mov_b32 s54, s53
    v_and_b32 v1, 15, v127
    v_lshrrev_b32 v2, 4, v127
    v_lshrrev_b32 v3, 1, v1
    v_xor_b32 v3, v3, v2
    v_lshlrev_b32 v4, 7, v1
    v_lshl_add_u32 v116, v3, 4, v4
    v_xor_b32 v117, 64, v116
    v_add_u32 v118, 65536, v116
    v_add_u32 v119, 65536, v117
    v_and_b32 v3, 1, v2
    v_bfe_u32 v4, v127, 2, 2
    v_bfe_u32 v5, v127, 1, 1
    v_and_b32 v6, 1, v127
    v_and_b32 v7, 2, v4
    v_lshl_or_b32 v7, v3, 2, v7
    s_lshl_b32 s56, s60, 1
    v_or_b32 v5, s56, v5
    v_xor_b32 v5, v5, v7
    v_lshl_add_u32 v4, v3, 3, v4
    v_lshlrev_b32 v4, 7, v4
    v_lshrrev_b32 v2, 5, v127
    v_lshl_add_u32 v4, v2, 12, v4
    v_lshl_add_u32 v4, v5, 4, v4
    v_lshl_add_u32 v120, v6, 3, v4
    v_add_u32 v121, 65536, v120
    v_and_b32 v1, 31, v127
    v_lshrrev_b32 v3, 4, v1
    v_mul_u32_u24 v3, 57344, v3
    v_and_b32 v4, 15, v1
    v_lshl_add_u32 v3, v4, 4, v3
    v_lshl_add_u32 v122, v2, 8, v3
    s_mul_i32 s62, s50, 917504
    s_lshl2_add_u32 s56, s51, s60
    s_lshl_b32 s56, s56, 9
    s_add_u32 s62, s62, s56
    s_add_u32 s62, s62, 1048576
    s_lshr_b32 s56, s48, 1
    s_lshl2_add_u32 s63, s50, s56
    s_mul_i32 s63, s63, 17408
    s_mov_b32 s14, 1
    v_mov_b32 v123, 0xc0135761
    s_mov_b32 s64, 0xbdd2d3e8
    s_waitcnt vmcnt(0) lgkmcnt(0)
    s_cmp_lt_u32 s49, 4
    s_cbranch_scc1 L_p1_idle
    s_mov_b64 exec, 0
    s_cmp_eq_u32 s60, 0
    s_cbranch_scc1 L_pad0
    s_cmp_eq_u32 s60, 1
    s_cbranch_scc1 L_pad1
    s_cmp_eq_u32 s60, 2
    s_cbranch_scc1 L_pad2
L_padend:
    s_mov_b64 exec, -1
    s_barrier
    ds_read_b64_tr_b16 a[0:1], v120 offset:16384
    ds_read_b64_tr_b16 a[2:3], v120 offset:16896
    ds_read_b128 v[64:67], v116 offset:0
    ds_read_b64_tr_b16 a[8:9], v120 offset:24576
    ds_read_b64_tr_b16 a[10:11], v120 offset:25088
    ds_read_b128 v[68:71], v117 offset:0
    ds_read_b64_tr_b16 a[4:5], v120 offset:18432
    ds_read_b64_tr_b16 a[6:7], v120 offset:18944
    ds_read_b64_tr_b16 a[12:13], v120 offset:26624
    ds_read_b64_tr_b16 a[14:15], v120 offset:27136
    ds_read_b128 v[72:75], v116 offset:2048
    ds_read_b128 v[76:79], v117 offset:2048
    s_waitcnt lgkmcnt(2)
    v_mfma_f32_16x16x32_bf16 v[0:3], a[0:3], v[64:67], 0
    ds_read_b128 v[80:83], v116 offset:4096
    v_mfma_f32_16x16x32_bf16 v[0:3], a[8:11], v[68:71], v[0:3]
    ds_read_b128 v[84:87], v117 offset:4096
    v_mfma_f32_16x16x32_bf16 v[8:11], a[4:7], v[64:67], 0
    ds_read_b128 v[88:91], v116 offset:6144
    v_mfma_f32_16x16x32_bf16 v[8:11], a[12:15], v[68:71], v[8:11]
    ds_read_b128 v[92:95], v117 offset:6144
    s_waitcnt lgkmcnt(4)
    v_mfma_f32_16x16x32_bf16 v[4:7], a[0:3], v[72:75], 0
    ds_read_b128 v[64:67], v116 offset:8192
    v_mfma_f32_16x16x32_bf16 v[4:7], a[8:11], v[76:79], v[4:7]
    ds_read_b128 v[68:71], v117 offset:8192
    v_mfma_f32_16x16x32_bf16 v[12:15], a[4:7], v[72:75], 0
    ds_read_b128 v[72:75], v116 offset:10240
    v_mfma_f32_16x16x32_bf16 v[12:15], a[12:15], v[76:79], v[12:15]
    ds_read_b128 v[76:79], v117 offset:10240
    s_waitcnt lgkmcnt(6)
    v_mfma_f32_16x16x32_bf16 v[16:19], a[0:3], v[80:83], 0
    v_mfma_f32_16x16x32_bf16 v[16:19], a[8:11], v[84:87], v[16:19]
    v_mfma_f32_16x16x32_bf16 v[24:27], a[4:7], v[80:83], 0
    ds_read_b128 v[80:83], v116 offset:12288
    v_mfma_f32_16x16x32_bf16 v[24:27], a[12:15], v[84:87], v[24:27]
    ds_read_b128 v[84:87], v117 offset:12288
    s_waitcnt lgkmcnt(6)
    v_mfma_f32_16x16x32_bf16 v[20:23], a[0:3], v[88:91], 0
    v_mfma_f32_16x16x32_bf16 v[20:23], a[8:11], v[92:95], v[20:23]
    v_mfma_f32_16x16x32_bf16 v[28:31], a[4:7], v[88:91], 0
    ds_read_b128 v[88:91], v116 offset:14336
    v_mfma_f32_16x16x32_bf16 v[28:31], a[12:15], v[92:95], v[28:31]
    ds_read_b128 v[92:95], v117 offset:14336
    s_waitcnt lgkmcnt(6)
    v_mfma_f32_16x16x32_bf16 v[32:35], a[0:3], v[64:67], 0
    v_mfma_f32_16x16x32_bf16 v[32:35], a[8:11], v[68:71], v[32:35]
    v_mfma_f32_16x16x32_bf16 v[40:43], a[4:7], v[64:67], 0
    s_waitcnt lgkmcnt(0)
    s_barrier
    ds_read_b64_tr_b16 a[16:17], v120 offset:49152
    v_mfma_f32_16x16x32_bf16 v[40:43], a[12:15], v[68:71], v[40:43]
    ds_read_b64_tr_b16 a[18:19], v120 offset:49664
    v_mfma_f32_16x16x32_bf16 v[36:39], a[0:3], v[72:75], 0
    ds_read_b128 v[64:67], v116 offset:32768
    v_mfma_f32_16x16x32_bf16 v[36:39], a[8:11], v[76:79], v[36:39]
    ds_read_b64_tr_b16 a[24:25], v120 offset:57344
    v_mfma_f32_16x16x32_bf16 v[44:47], a[4:7], v[72:75], 0
    ds_read_b64_tr_b16 a[26:27], v120 offset:57856
    v_mfma_f32_16x16x32_bf16 v[44:47], a[12:15], v[76:79], v[44:47]
    ds_read_b128 v[68:71], v117 offset:32768
    v_mfma_f32_16x16x32_bf16 v[48:51], a[0:3], v[80:83], 0
    ds_read_b64_tr_b16 a[20:21], v120 offset:51200
    v_mfma_f32_16x16x32_bf16 v[48:51], a[8:11], v[84:87], v[48:51]
    ds_read_b64_tr_b16 a[22:23], v120 offset:51712
    v_mfma_f32_16x16x32_bf16 v[56:59], a[4:7], v[80:83], 0
    ds_read_b64_tr_b16 a[28:29], v120 offset:59392
    v_mfma_f32_16x16x32_bf16 v[56:59], a[12:15], v[84:87], v[56:59]
    ds_read_b64_tr_b16 a[30:31], v120 offset:59904
    v_mfma_f32_16x16x32_bf16 v[52:55], a[0:3], v[88:91], 0
    ds_read_b128 v[72:75], v116 offset:34816
    v_mfma_f32_16x16x32_bf16 v[52:55], a[8:11], v[92:95], v[52:55]
    ds_read_b128 v[76:79], v117 offset:34816
    v_mfma_f32_16x16x32_bf16 v[60:63], a[4:7], v[88:91], 0
    ds_read_b128 v[80:83], v116 offset:36864
    v_mfma_f32_16x16x32_bf16 v[60:63], a[12:15], v[92:95], v[60:63]
    ds_read_b128 v[84:87], v117 offset:36864
    s_waitcnt lgkmcnt(4)
    v_mfma_f32_16x16x32_bf16 v[0:3], a[16:19], v[64:67], v[0:3]
    ds_read_b128 v[88:91], v116 offset:38912
    v_mfma_f32_16x16x32_bf16 v[0:3], a[24:27], v[68:71], v[0:3]
    ds_read_b128 v[92:95], v117 offset:38912
    v_mfma_f32_16x16x32_bf16 v[8:11], a[20:23], v[64:67], v[8:11]
    ds_read_b128 v[64:67], v116 offset:40960
    v_mfma_f32_16x16x32_bf16 v[8:11], a[28:31], v[68:71], v[8:11]
    ds_read_b128 v[68:71], v117 offset:40960
    s_waitcnt lgkmcnt(6)
    v_mfma_f32_16x16x32_bf16 v[4:7], a[16:19], v[72:75], v[4:7]
    v_mfma_f32_16x16x32_bf16 v[4:7], a[24:27], v[76:79], v[4:7]
    v_mfma_f32_16x16x32_bf16 v[12:15], a[20:23], v[72:75], v[12:15]
    ds_read_b128 v[72:75], v116 offset:43008
    v_mfma_f32_16x16x32_bf16 v[12:15], a[28:31], v[76:79], v[12:15]
    ds_read_b128 v[76:79], v117 offset:43008
    s_waitcnt lgkmcnt(6)
    v_mfma_f32_16x16x32_bf16 v[16:19], a[16:19], v[80:83], v[16:19]
    v_mfma_f32_16x16x32_bf16 v[16:19], a[24:27], v[84:87], v[16:19]
    v_mfma_f32_16x16x32_bf16 v[24:27], a[20:23], v[80:83], v[24:27]
    ds_read_b128 v[80:83], v116 offset:45056
    v_mfma_f32_16x16x32_bf16 v[24:27], a[28:31], v[84:87], v[24:27]
    ds_read_b128 v[84:87], v117 offset:45056
    s_waitcnt lgkmcnt(6)
    v_mfma_f32_16x16x32_bf16 v[20:23], a[16:19], v[88:91], v[20:23]
    v_mfma_f32_16x16x32_bf16 v[20:23], a[24:27], v[92:95], v[20:23]
    v_mfma_f32_16x16x32_bf16 v[28:31], a[20:23], v[88:91], v[28:31]
    ds_read_b128 v[88:91], v116 offset:47104
    v_mfma_f32_16x16x32_bf16 v[28:31], a[28:31], v[92:95], v[28:31]
    ds_read_b128 v[92:95], v117 offset:47104
    s_waitcnt lgkmcnt(6)
    v_mfma_f32_16x16x32_bf16 v[32:35], a[16:19], v[64:67], v[32:35]
    v_mfma_f32_16x16x32_bf16 v[32:35], a[24:27], v[68:71], v[32:35]
    v_mfma_f32_16x16x32_bf16 v[40:43], a[20:23], v[64:67], v[40:43]
    s_waitcnt lgkmcnt(0)
    s_barrier
    ds_read_b64_tr_b16 a[32:33], v121 offset:16384
    v_mfma_f32_16x16x32_bf16 v[40:43], a[28:31], v[68:71], v[40:43]
    ds_read_b64_tr_b16 a[34:35], v121 offset:16896
    v_mfma_f32_16x16x32_bf16 v[36:39], a[16:19], v[72:75], v[36:39]
    ds_read_b128 v[64:67], v118 offset:0
    v_mfma_f32_16x16x32_bf16 v[36:39], a[24:27], v[76:79], v[36:39]
    ds_read_b64_tr_b16 a[40:41], v121 offset:24576
    v_mfma_f32_16x16x32_bf16 v[44:47], a[20:23], v[72:75], v[44:47]
    ds_read_b64_tr_b16 a[42:43], v121 offset:25088
    v_mfma_f32_16x16x32_bf16 v[44:47], a[28:31], v[76:79], v[44:47]
    ds_read_b128 v[68:71], v119 offset:0
    v_mfma_f32_16x16x32_bf16 v[48:51], a[16:19], v[80:83], v[48:51]
    ds_read_b64_tr_b16 a[36:37], v121 offset:18432
    v_mfma_f32_16x16x32_bf16 v[48:51], a[24:27], v[84:87], v[48:51]
    ds_read_b64_tr_b16 a[38:39], v121 offset:18944
    v_mfma_f32_16x16x32_bf16 v[56:59], a[20:23], v[80:83], v[56:59]
    ds_read_b64_tr_b16 a[44:45], v121 offset:26624
    v_mfma_f32_16x16x32_bf16 v[56:59], a[28:31], v[84:87], v[56:59]
    ds_read_b64_tr_b16 a[46:47], v121 offset:27136
    v_mfma_f32_16x16x32_bf16 v[52:55], a[16:19], v[88:91], v[52:55]
    ds_read_b128 v[72:75], v118 offset:2048
    v_mfma_f32_16x16x32_bf16 v[52:55], a[24:27], v[92:95], v[52:55]
    ds_read_b128 v[76:79], v119 offset:2048
    v_mfma_f32_16x16x32_bf16 v[60:63], a[20:23], v[88:91], v[60:63]
    ds_read_b128 v[80:83], v118 offset:4096
    v_mfma_f32_16x16x32_bf16 v[60:63], a[28:31], v[92:95], v[60:63]
    ds_read_b128 v[84:87], v119 offset:4096
    s_waitcnt lgkmcnt(4)
    v_mfma_f32_16x16x32_bf16 v[0:3], a[32:35], v[64:67], v[0:3]
    ds_read_b128 v[88:91], v118 offset:6144
    v_mfma_f32_16x16x32_bf16 v[0:3], a[40:43], v[68:71], v[0:3]
    ds_read_b128 v[92:95], v119 offset:6144
    v_mfma_f32_16x16x32_bf16 v[8:11], a[36:39], v[64:67], v[8:11]
    ds_read_b128 v[64:67], v118 offset:8192
    v_mfma_f32_16x16x32_bf16 v[8:11], a[44:47], v[68:71], v[8:11]
    ds_read_b128 v[68:71], v119 offset:8192
    s_waitcnt lgkmcnt(6)
    v_mfma_f32_16x16x32_bf16 v[4:7], a[32:35], v[72:75], v[4:7]
    v_mfma_f32_16x16x32_bf16 v[4:7], a[40:43], v[76:79], v[4:7]
    v_mfma_f32_16x16x32_bf16 v[12:15], a[36:39], v[72:75], v[12:15]
    ds_read_b128 v[72:75], v118 offset:10240
    v_mfma_f32_16x16x32_bf16 v[12:15], a[44:47], v[76:79], v[12:15]
    ds_read_b128 v[76:79], v119 offset:10240
    s_waitcnt lgkmcnt(6)
    v_mfma_f32_16x16x32_bf16 v[16:19], a[32:35], v[80:83], v[16:19]
    v_mfma_f32_16x16x32_bf16 v[16:19], a[40:43], v[84:87], v[16:19]
    v_mfma_f32_16x16x32_bf16 v[24:27], a[36:39], v[80:83], v[24:27]
    ds_read_b128 v[80:83], v118 offset:12288
    v_mfma_f32_16x16x32_bf16 v[24:27], a[44:47], v[84:87], v[24:27]
    ds_read_b128 v[84:87], v119 offset:12288
    s_waitcnt lgkmcnt(6)
    v_mfma_f32_16x16x32_bf16 v[20:23], a[32:35], v[88:91], v[20:23]
    v_mfma_f32_16x16x32_bf16 v[20:23], a[40:43], v[92:95], v[20:23]
    v_mfma_f32_16x16x32_bf16 v[28:31], a[36:39], v[88:91], v[28:31]
    ds_read_b128 v[88:91], v118 offset:14336
    v_mfma_f32_16x16x32_bf16 v[28:31], a[44:47], v[92:95], v[28:31]
    ds_read_b128 v[92:95], v119 offset:14336
    s_waitcnt lgkmcnt(6)
    v_mfma_f32_16x16x32_bf16 v[32:35], a[32:35], v[64:67], v[32:35]
    v_mfma_f32_16x16x32_bf16 v[32:35], a[40:43], v[68:71], v[32:35]
    v_mfma_f32_16x16x32_bf16 v[40:43], a[36:39], v[64:67], v[40:43]
    s_waitcnt lgkmcnt(0)
    s_barrier
    ds_read_b64_tr_b16 a[48:49], v120 offset:16384
    v_mfma_f32_16x16x32_bf16 v[40:43], a[44:47], v[68:71], v[40:43]
    ds_read_b64_tr_b16 a[50:51], v120 offset:16896
    v_mfma_f32_16x16x32_bf16 v[36:39], a[32:35], v[72:75], v[36:39]
    ds_read_b128 v[64:67], v116 offset:0
    v_mfma_f32_16x16x32_bf16 v[36:39], a[40:43], v[76:79], v[36:39]
    ds_read_b64_tr_b16 a[56:57], v120 offset:24576
    v_mfma_f32_16x16x32_bf16 v[44:47], a[36:39], v[72:75], v[44:47]
    ds_read_b64_tr_b16 a[58:59], v120 offset:25088
    v_mfma_f32_16x16x32_bf16 v[44:47], a[44:47], v[76:79], v[44:47]
    ds_read_b128 v[68:71], v117 offset:0
    v_mfma_f32_16x16x32_bf16 v[48:51], a[32:35], v[80:83], v[48:51]
    ds_read_b64_tr_b16 a[52:53], v120 offset:18432
    v_mfma_f32_16x16x32_bf16 v[48:51], a[40:43], v[84:87], v[48:51]
    ds_read_b64_tr_b16 a[54:55], v120 offset:18944
    v_mfma_f32_16x16x32_bf16 v[56:59], a[36:39], v[80:83], v[56:59]
    ds_read_b64_tr_b16 a[60:61], v120 offset:26624
    v_mfma_f32_16x16x32_bf16 v[56:59], a[44:47], v[84:87], v[56:59]
    ds_read_b64_tr_b16 a[62:63], v120 offset:27136
    v_mfma_f32_16x16x32_bf16 v[52:55], a[32:35], v[88:91], v[52:55]
    ds_read_b128 v[72:75], v116 offset:2048
    v_mfma_f32_16x16x32_bf16 v[52:55], a[40:43], v[92:95], v[52:55]
    ds_read_b128 v[76:79], v117 offset:2048
    v_mfma_f32_16x16x32_bf16 v[60:63], a[36:39], v[88:91], v[60:63]
    ds_read_b128 v[80:83], v116 offset:4096
    v_mfma_f32_16x16x32_bf16 v[60:63], a[44:47], v[92:95], v[60:63]
    ds_read_b128 v[84:87], v117 offset:4096
    s_waitcnt lgkmcnt(4)
    v_mfma_f32_16x16x32_bf16 v[0:3], a[48:51], v[64:67], v[0:3]
    ds_read_b128 v[88:91], v116 offset:6144
    v_mfma_f32_16x16x32_bf16 v[0:3], a[56:59], v[68:71], v[0:3]
    ds_read_b128 v[92:95], v117 offset:6144
    v_mfma_f32_16x16x32_bf16 v[8:11], a[52:55], v[64:67], v[8:11]
    ds_read_b128 v[64:67], v116 offset:8192
    v_mfma_f32_16x16x32_bf16 v[8:11], a[60:63], v[68:71], v[8:11]
    ds_read_b128 v[68:71], v117 offset:8192
    s_waitcnt lgkmcnt(6)
    v_mfma_f32_16x16x32_bf16 v[4:7], a[48:51], v[72:75], v[4:7]
    v_mfma_f32_16x16x32_bf16 v[4:7], a[56:59], v[76:79], v[4:7]
    v_mfma_f32_16x16x32_bf16 v[12:15], a[52:55], v[72:75], v[12:15]
    ds_read_b128 v[72:75], v116 offset:10240
    v_mfma_f32_16x16x32_bf16 v[12:15], a[60:63], v[76:79], v[12:15]
    ds_read_b128 v[76:79], v117 offset:10240
    s_waitcnt lgkmcnt(6)
    v_mfma_f32_16x16x32_bf16 v[16:19], a[48:51], v[80:83], v[16:19]
    v_mfma_f32_16x16x32_bf16 v[16:19], a[56:59], v[84:87], v[16:19]
    v_mfma_f32_16x16x32_bf16 v[24:27], a[52:55], v[80:83], v[24:27]
    ds_read_b128 v[80:83], v116 offset:12288
    v_mfma_f32_16x16x32_bf16 v[24:27], a[60:63], v[84:87], v[24:27]
    ds_read_b128 v[84:87], v117 offset:12288
    s_waitcnt lgkmcnt(6)
    v_mfma_f32_16x16x32_bf16 v[20:23], a[48:51], v[88:91], v[20:23]
    v_mfma_f32_16x16x32_bf16 v[20:23], a[56:59], v[92:95], v[20:23]
    v_mfma_f32_16x16x32_bf16 v[28:31], a[52:55], v[88:91], v[28:31]
    ds_read_b128 v[88:91], v116 offset:14336
    v_mfma_f32_16x16x32_bf16 v[28:31], a[60:63], v[92:95], v[28:31]
    ds_read_b128 v[92:95], v117 offset:14336
    s_waitcnt lgkmcnt(6)
    v_mfma_f32_16x16x32_bf16 v[32:35], a[48:51], v[64:67], v[32:35]
    v_mfma_f32_16x16x32_bf16 v[32:35], a[56:59], v[68:71], v[32:35]
    v_mfma_f32_16x16x32_bf16 v[40:43], a[52:55], v[64:67], v[40:43]
    s_waitcnt lgkmcnt(0)
    s_barrier
    ds_read_b64_tr_b16 a[64:65], v120 offset:49152
    v_mfma_f32_16x16x32_bf16 v[40:43], a[60:63], v[68:71], v[40:43]
    ds_read_b64_tr_b16 a[66:67], v120 offset:49664
    v_mfma_f32_16x16x32_bf16 v[36:39], a[48:51], v[72:75], v[36:39]
    ds_read_b128 v[64:67], v116 offset:32768
    v_mfma_f32_16x16x32_bf16 v[36:39], a[56:59], v[76:79], v[36:39]
    ds_read_b64_tr_b16 a[72:73], v120 offset:57344
    v_mfma_f32_16x16x32_bf16 v[44:47], a[52:55], v[72:75], v[44:47]
    ds_read_b64_tr_b16 a[74:75], v120 offset:57856
    v_mfma_f32_16x16x32_bf16 v[44:47], a[60:63], v[76:79], v[44:47]
    ds_read_b128 v[68:71], v117 offset:32768
    v_mfma_f32_16x16x32_bf16 v[48:51], a[48:51], v[80:83], v[48:51]
    ds_read_b64_tr_b16 a[68:69], v120 offset:51200
    v_mfma_f32_16x16x32_bf16 v[48:51], a[56:59], v[84:87], v[48:51]
    ds_read_b64_tr_b16 a[70:71], v120 offset:51712
    v_mfma_f32_16x16x32_bf16 v[56:59], a[52:55], v[80:83], v[56:59]
    ds_read_b64_tr_b16 a[76:77], v120 offset:59392
    v_mfma_f32_16x16x32_bf16 v[56:59], a[60:63], v[84:87], v[56:59]
    ds_read_b64_tr_b16 a[78:79], v120 offset:59904
    v_mfma_f32_16x16x32_bf16 v[52:55], a[48:51], v[88:91], v[52:55]
    ds_read_b128 v[72:75], v116 offset:34816
    v_mfma_f32_16x16x32_bf16 v[52:55], a[56:59], v[92:95], v[52:55]
    ds_read_b128 v[76:79], v117 offset:34816
    v_mfma_f32_16x16x32_bf16 v[60:63], a[52:55], v[88:91], v[60:63]
    ds_read_b128 v[80:83], v116 offset:36864
    v_mfma_f32_16x16x32_bf16 v[60:63], a[60:63], v[92:95], v[60:63]
    ds_read_b128 v[84:87], v117 offset:36864
    s_waitcnt lgkmcnt(4)
    v_mfma_f32_16x16x32_bf16 v[0:3], a[64:67], v[64:67], v[0:3]
    ds_read_b128 v[88:91], v116 offset:38912
    v_mfma_f32_16x16x32_bf16 v[0:3], a[72:75], v[68:71], v[0:3]
    ds_read_b128 v[92:95], v117 offset:38912
    v_mfma_f32_16x16x32_bf16 v[8:11], a[68:71], v[64:67], v[8:11]
    ds_read_b128 v[64:67], v116 offset:40960
    v_mfma_f32_16x16x32_bf16 v[8:11], a[76:79], v[68:71], v[8:11]
    ds_read_b128 v[68:71], v117 offset:40960
    s_waitcnt lgkmcnt(6)
    v_mfma_f32_16x16x32_bf16 v[4:7], a[64:67], v[72:75], v[4:7]
    v_mfma_f32_16x16x32_bf16 v[4:7], a[72:75], v[76:79], v[4:7]
    v_mfma_f32_16x16x32_bf16 v[12:15], a[68:71], v[72:75], v[12:15]
    ds_read_b128 v[72:75], v116 offset:43008
    v_mfma_f32_16x16x32_bf16 v[12:15], a[76:79], v[76:79], v[12:15]
    ds_read_b128 v[76:79], v117 offset:43008
    s_waitcnt lgkmcnt(6)
    v_mfma_f32_16x16x32_bf16 v[16:19], a[64:67], v[80:83], v[16:19]
    v_mfma_f32_16x16x32_bf16 v[16:19], a[72:75], v[84:87], v[16:19]
    v_mfma_f32_16x16x32_bf16 v[24:27], a[68:71], v[80:83], v[24:27]
    ds_read_b128 v[80:83], v116 offset:45056
    v_mfma_f32_16x16x32_bf16 v[24:27], a[76:79], v[84:87], v[24:27]
    ds_read_b128 v[84:87], v117 offset:45056
    s_waitcnt lgkmcnt(6)
    v_mfma_f32_16x16x32_bf16 v[20:23], a[64:67], v[88:91], v[20:23]
    v_mfma_f32_16x16x32_bf16 v[20:23], a[72:75], v[92:95], v[20:23]
    v_mfma_f32_16x16x32_bf16 v[28:31], a[68:71], v[88:91], v[28:31]
    ds_read_b128 v[88:91], v116 offset:47104
    v_mfma_f32_16x16x32_bf16 v[28:31], a[76:79], v[92:95], v[28:31]
    ds_read_b128 v[92:95], v117 offset:47104
    s_waitcnt lgkmcnt(6)
    v_mfma_f32_16x16x32_bf16 v[32:35], a[64:67], v[64:67], v[32:35]
    v_mfma_f32_16x16x32_bf16 v[32:35], a[72:75], v[68:71], v[32:35]
    v_mfma_f32_16x16x32_bf16 v[40:43], a[68:71], v[64:67], v[40:43]
    s_waitcnt lgkmcnt(0)
    s_barrier
    ds_read_b64_tr_b16 a[80:81], v121 offset:16384
    v_mfma_f32_16x16x32_bf16 v[40:43], a[76:79], v[68:71], v[40:43]
    ds_read_b64_tr_b16 a[82:83], v121 offset:16896
    v_mfma_f32_16x16x32_bf16 v[36:39], a[64:67], v[72:75], v[36:39]
    ds_read_b128 v[64:67], v118 offset:0
    v_mfma_f32_16x16x32_bf16 v[36:39], a[72:75], v[76:79], v[36:39]
    ds_read_b64_tr_b16 a[88:89], v121 offset:24576
    v_mfma_f32_16x16x32_bf16 v[44:47], a[68:71], v[72:75], v[44:47]
    ds_read_b64_tr_b16 a[90:91], v121 offset:25088
    v_mfma_f32_16x16x32_bf16 v[44:47], a[76:79], v[76:79], v[44:47]
    ds_read_b128 v[68:71], v119 offset:0
    v_mfma_f32_16x16x32_bf16 v[48:51], a[64:67], v[80:83], v[48:51]
    ds_read_b64_tr_b16 a[84:85], v121 offset:18432
    v_mfma_f32_16x16x32_bf16 v[48:51], a[72:75], v[84:87], v[48:51]
    ds_read_b64_tr_b16 a[86:87], v121 offset:18944
    v_mfma_f32_16x16x32_bf16 v[56:59], a[68:71], v[80:83], v[56:59]
    ds_read_b64_tr_b16 a[92:93], v121 offset:26624
    v_mfma_f32_16x16x32_bf16 v[56:59], a[76:79], v[84:87], v[56:59]
    ds_read_b64_tr_b16 a[94:95], v121 offset:27136
    v_mfma_f32_16x16x32_bf16 v[52:55], a[64:67], v[88:91], v[52:55]
    ds_read_b128 v[72:75], v118 offset:2048
    v_mfma_f32_16x16x32_bf16 v[52:55], a[72:75], v[92:95], v[52:55]
    ds_read_b128 v[76:79], v119 offset:2048
    v_mfma_f32_16x16x32_bf16 v[60:63], a[68:71], v[88:91], v[60:63]
    ds_read_b128 v[80:83], v118 offset:4096
    v_mfma_f32_16x16x32_bf16 v[60:63], a[76:79], v[92:95], v[60:63]
    ds_read_b128 v[84:87], v119 offset:4096
    s_waitcnt lgkmcnt(4)
    v_mfma_f32_16x16x32_bf16 v[0:3], a[80:83], v[64:67], v[0:3]
    ds_read_b128 v[88:91], v118 offset:6144
    v_mfma_f32_16x16x32_bf16 v[0:3], a[88:91], v[68:71], v[0:3]
    ds_read_b128 v[92:95], v119 offset:6144
    v_mfma_f32_16x16x32_bf16 v[8:11], a[84:87], v[64:67], v[8:11]
    ds_read_b128 v[64:67], v118 offset:8192
    v_mfma_f32_16x16x32_bf16 v[8:11], a[92:95], v[68:71], v[8:11]
    ds_read_b128 v[68:71], v119 offset:8192
    s_waitcnt lgkmcnt(6)
    v_mfma_f32_16x16x32_bf16 v[4:7], a[80:83], v[72:75], v[4:7]
    v_mfma_f32_16x16x32_bf16 v[4:7], a[88:91], v[76:79], v[4:7]
    v_mfma_f32_16x16x32_bf16 v[12:15], a[84:87], v[72:75], v[12:15]
    ds_read_b128 v[72:75], v118 offset:10240
    v_mfma_f32_16x16x32_bf16 v[12:15], a[92:95], v[76:79], v[12:15]
    ds_read_b128 v[76:79], v119 offset:10240
    s_waitcnt lgkmcnt(6)
    v_mfma_f32_16x16x32_bf16 v[16:19], a[80:83], v[80:83], v[16:19]
    v_mfma_f32_16x16x32_bf16 v[16:19], a[88:91], v[84:87], v[16:19]
    v_mfma_f32_16x16x32_bf16 v[24:27], a[84:87], v[80:83], v[24:27]
    ds_read_b128 v[80:83], v118 offset:12288
    v_mfma_f32_16x16x32_bf16 v[24:27], a[92:95], v[84:87], v[24:27]
    ds_read_b128 v[84:87], v119 offset:12288
    s_waitcnt lgkmcnt(6)
    v_mfma_f32_16x16x32_bf16 v[20:23], a[80:83], v[88:91], v[20:23]
    v_mfma_f32_16x16x32_bf16 v[20:23], a[88:91], v[92:95], v[20:23]
    v_mfma_f32_16x16x32_bf16 v[28:31], a[84:87], v[88:91], v[28:31]
    ds_read_b128 v[88:91], v118 offset:14336
    v_mfma_f32_16x16x32_bf16 v[28:31], a[92:95], v[92:95], v[28:31]
    ds_read_b128 v[92:95], v119 offset:14336
    s_waitcnt lgkmcnt(6)
    v_mfma_f32_16x16x32_bf16 v[32:35], a[80:83], v[64:67], v[32:35]
    v_mfma_f32_16x16x32_bf16 v[32:35], a[88:91], v[68:71], v[32:35]
    v_mfma_f32_16x16x32_bf16 v[40:43], a[84:87], v[64:67], v[40:43]
    s_waitcnt lgkmcnt(0)
    s_barrier
    ds_read_b64_tr_b16 a[96:97], v120 offset:16384
    v_mfma_f32_16x16x32_bf16 v[40:43], a[92:95], v[68:71], v[40:43]
    ds_read_b64_tr_b16 a[98:99], v120 offset:16896
    v_mfma_f32_16x16x32_bf16 v[36:39], a[80:83], v[72:75], v[36:39]
    ds_read_b128 v[64:67], v116 offset:0
    v_mfma_f32_16x16x32_bf16 v[36:39], a[88:91], v[76:79], v[36:39]
    ds_read_b64_tr_b16 a[104:105], v120 offset:24576
    v_mfma_f32_16x16x32_bf16 v[44:47], a[84:87], v[72:75], v[44:47]
    ds_read_b64_tr_b16 a[106:107], v120 offset:25088
    v_mfma_f32_16x16x32_bf16 v[44:47], a[92:95], v[76:79], v[44:47]
    ds_read_b128 v[68:71], v117 offset:0
    v_mfma_f32_16x16x32_bf16 v[48:51], a[80:83], v[80:83], v[48:51]
    ds_read_b64_tr_b16 a[100:101], v120 offset:18432
    v_mfma_f32_16x16x32_bf16 v[48:51], a[88:91], v[84:87], v[48:51]
    ds_read_b64_tr_b16 a[102:103], v120 offset:18944
    v_mfma_f32_16x16x32_bf16 v[56:59], a[84:87], v[80:83], v[56:59]
    ds_read_b64_tr_b16 a[108:109], v120 offset:26624
    v_mfma_f32_16x16x32_bf16 v[56:59], a[92:95], v[84:87], v[56:59]
    ds_read_b64_tr_b16 a[110:111], v120 offset:27136
    v_mfma_f32_16x16x32_bf16 v[52:55], a[80:83], v[88:91], v[52:55]
    ds_read_b128 v[72:75], v116 offset:2048
    v_mfma_f32_16x16x32_bf16 v[52:55], a[88:91], v[92:95], v[52:55]
    ds_read_b128 v[76:79], v117 offset:2048
    v_mfma_f32_16x16x32_bf16 v[60:63], a[84:87], v[88:91], v[60:63]
    ds_read_b128 v[80:83], v116 offset:4096
    v_mfma_f32_16x16x32_bf16 v[60:63], a[92:95], v[92:95], v[60:63]
    ds_read_b128 v[84:87], v117 offset:4096
    s_waitcnt lgkmcnt(4)
    v_mfma_f32_16x16x32_bf16 v[0:3], a[96:99], v[64:67], v[0:3]
    ds_read_b128 v[88:91], v116 offset:6144
    v_mfma_f32_16x16x32_bf16 v[0:3], a[104:107], v[68:71], v[0:3]
    ds_read_b128 v[92:95], v117 offset:6144
    v_mfma_f32_16x16x32_bf16 v[8:11], a[100:103], v[64:67], v[8:11]
    ds_read_b128 v[64:67], v116 offset:8192
    v_mfma_f32_16x16x32_bf16 v[8:11], a[108:111], v[68:71], v[8:11]
    ds_read_b128 v[68:71], v117 offset:8192
    s_waitcnt lgkmcnt(6)
    v_mfma_f32_16x16x32_bf16 v[4:7], a[96:99], v[72:75], v[4:7]
    v_mfma_f32_16x16x32_bf16 v[4:7], a[104:107], v[76:79], v[4:7]
    v_mfma_f32_16x16x32_bf16 v[12:15], a[100:103], v[72:75], v[12:15]
    ds_read_b128 v[72:75], v116 offset:10240
    v_mfma_f32_16x16x32_bf16 v[12:15], a[108:111], v[76:79], v[12:15]
    ds_read_b128 v[76:79], v117 offset:10240
    s_waitcnt lgkmcnt(6)
    v_mfma_f32_16x16x32_bf16 v[16:19], a[96:99], v[80:83], v[16:19]
    v_mfma_f32_16x16x32_bf16 v[16:19], a[104:107], v[84:87], v[16:19]
    v_mfma_f32_16x16x32_bf16 v[24:27], a[100:103], v[80:83], v[24:27]
    ds_read_b128 v[80:83], v116 offset:12288
    v_mfma_f32_16x16x32_bf16 v[24:27], a[108:111], v[84:87], v[24:27]
    ds_read_b128 v[84:87], v117 offset:12288
    s_waitcnt lgkmcnt(6)
    v_mfma_f32_16x16x32_bf16 v[20:23], a[96:99], v[88:91], v[20:23]
    v_mfma_f32_16x16x32_bf16 v[20:23], a[104:107], v[92:95], v[20:23]
    v_mfma_f32_16x16x32_bf16 v[28:31], a[100:103], v[88:91], v[28:31]
    ds_read_b128 v[88:91], v116 offset:14336
    v_mfma_f32_16x16x32_bf16 v[28:31], a[108:111], v[92:95], v[28:31]
    ds_read_b128 v[92:95], v117 offset:14336
    s_waitcnt lgkmcnt(6)
    v_mfma_f32_16x16x32_bf16 v[32:35], a[96:99], v[64:67], v[32:35]
    v_mfma_f32_16x16x32_bf16 v[32:35], a[104:107], v[68:71], v[32:35]
    v_mfma_f32_16x16x32_bf16 v[40:43], a[100:103], v[64:67], v[40:43]
    s_waitcnt lgkmcnt(0)
    s_barrier
    ds_read_b64_tr_b16 a[112:113], v120 offset:49152
    v_mfma_f32_16x16x32_bf16 v[40:43], a[108:111], v[68:71], v[40:43]
    ds_read_b64_tr_b16 a[114:115], v120 offset:49664
    v_mfma_f32_16x16x32_bf16 v[36:39], a[96:99], v[72:75], v[36:39]
    ds_read_b128 v[64:67], v116 offset:32768
    v_mfma_f32_16x16x32_bf16 v[36:39], a[104:107], v[76:79], v[36:39]
    ds_read_b64_tr_b16 a[120:121], v120 offset:57344
    v_mfma_f32_16x16x32_bf16 v[44:47], a[100:103], v[72:75], v[44:47]
    ds_read_b64_tr_b16 a[122:123], v120 offset:57856
    v_mfma_f32_16x16x32_bf16 v[44:47], a[108:111], v[76:79], v[44:47]
    ds_read_b128 v[68:71], v117 offset:32768
    v_mfma_f32_16x16x32_bf16 v[48:51], a[96:99], v[80:83], v[48:51]
    ds_read_b64_tr_b16 a[116:117], v120 offset:51200
    v_mfma_f32_16x16x32_bf16 v[48:51], a[104:107], v[84:87], v[48:51]
    ds_read_b64_tr_b16 a[118:119], v120 offset:51712
    v_mfma_f32_16x16x32_bf16 v[56:59], a[100:103], v[80:83], v[56:59]
    ds_read_b64_tr_b16 a[124:125], v120 offset:59392
    v_mfma_f32_16x16x32_bf16 v[56:59], a[108:111], v[84:87], v[56:59]
    ds_read_b64_tr_b16 a[126:127], v120 offset:59904
    v_mfma_f32_16x16x32_bf16 v[52:55], a[96:99], v[88:91], v[52:55]
    ds_read_b128 v[72:75], v116 offset:34816
    v_mfma_f32_16x16x32_bf16 v[52:55], a[104:107], v[92:95], v[52:55]
    ds_read_b128 v[76:79], v117 offset:34816
    v_mfma_f32_16x16x32_bf16 v[60:63], a[100:103], v[88:91], v[60:63]
    ds_read_b128 v[80:83], v116 offset:36864
    v_mfma_f32_16x16x32_bf16 v[60:63], a[108:111], v[92:95], v[60:63]
    ds_read_b128 v[84:87], v117 offset:36864
    s_waitcnt lgkmcnt(4)
    v_mfma_f32_16x16x32_bf16 v[0:3], a[112:115], v[64:67], v[0:3]
    ds_read_b128 v[88:91], v116 offset:38912
    v_mfma_f32_16x16x32_bf16 v[0:3], a[120:123], v[68:71], v[0:3]
    ds_read_b128 v[92:95], v117 offset:38912
    v_mfma_f32_16x16x32_bf16 v[8:11], a[116:119], v[64:67], v[8:11]
    ds_read_b128 v[64:67], v116 offset:40960
    v_mfma_f32_16x16x32_bf16 v[8:11], a[124:127], v[68:71], v[8:11]
    ds_read_b128 v[68:71], v117 offset:40960
    s_waitcnt lgkmcnt(6)
    v_mfma_f32_16x16x32_bf16 v[4:7], a[112:115], v[72:75], v[4:7]
    v_mfma_f32_16x16x32_bf16 v[4:7], a[120:123], v[76:79], v[4:7]
    v_mfma_f32_16x16x32_bf16 v[12:15], a[116:119], v[72:75], v[12:15]
    ds_read_b128 v[72:75], v116 offset:43008
    v_mfma_f32_16x16x32_bf16 v[12:15], a[124:127], v[76:79], v[12:15]
    ds_read_b128 v[76:79], v117 offset:43008
    s_waitcnt lgkmcnt(6)
    v_mfma_f32_16x16x32_bf16 v[16:19], a[112:115], v[80:83], v[16:19]
    v_mfma_f32_16x16x32_bf16 v[16:19], a[120:123], v[84:87], v[16:19]
    v_mfma_f32_16x16x32_bf16 v[24:27], a[116:119], v[80:83], v[24:27]
    ds_read_b128 v[80:83], v116 offset:45056
    v_mfma_f32_16x16x32_bf16 v[24:27], a[124:127], v[84:87], v[24:27]
    ds_read_b128 v[84:87], v117 offset:45056
    s_waitcnt lgkmcnt(6)
    v_mfma_f32_16x16x32_bf16 v[20:23], a[112:115], v[88:91], v[20:23]
    v_mfma_f32_16x16x32_bf16 v[20:23], a[120:123], v[92:95], v[20:23]
    v_mfma_f32_16x16x32_bf16 v[28:31], a[116:119], v[88:91], v[28:31]
    ds_read_b128 v[88:91], v116 offset:47104
    v_mfma_f32_16x16x32_bf16 v[28:31], a[124:127], v[92:95], v[28:31]
    ds_read_b128 v[92:95], v117 offset:47104
    s_waitcnt lgkmcnt(6)
    v_mfma_f32_16x16x32_bf16 v[32:35], a[112:115], v[64:67], v[32:35]
L_pad1:
    s_cbranch_execz L_padend
    v_mfma_f32_16x16x32_bf16 v[32:35], a[120:123], v[68:71], v[32:35]
    v_mfma_f32_16x16x32_bf16 v[40:43], a[116:119], v[64:67], v[40:43]
    s_waitcnt lgkmcnt(0)
    s_barrier
    ds_read_b128 v[108:111], v118 offset:0
    v_mfma_f32_16x16x32_bf16 v[40:43], a[124:127], v[68:71], v[40:43]
    ds_read_b128 v[112:115], v119 offset:0
    v_mfma_f32_16x16x32_bf16 v[36:39], a[112:115], v[72:75], v[36:39]
    ds_read_b128 v[96:99], v118 offset:2048
    v_mfma_f32_16x16x32_bf16 v[36:39], a[120:123], v[76:79], v[36:39]
    ds_read_b128 v[100:103], v119 offset:2048
    v_mfma_f32_16x16x32_bf16 v[44:47], a[116:119], v[72:75], v[44:47]
    ds_read_b128 v[104:107], v118 offset:4096
    v_mfma_f32_16x16x32_bf16 v[44:47], a[124:127], v[76:79], v[44:47]
    v_mfma_f32_16x16x32_bf16 v[48:51], a[112:115], v[80:83], v[48:51]
    v_mfma_f32_16x16x32_bf16 v[48:51], a[120:123], v[84:87], v[48:51]
    v_mfma_f32_16x16x32_bf16 v[56:59], a[116:119], v[80:83], v[56:59]
    v_mfma_f32_16x16x32_bf16 v[56:59], a[124:127], v[84:87], v[56:59]
    v_mfma_f32_16x16x32_bf16 v[52:55], a[112:115], v[88:91], v[52:55]
    v_mfma_f32_16x16x32_bf16 v[52:55], a[120:123], v[92:95], v[52:55]
    v_mfma_f32_16x16x32_bf16 v[60:63], a[116:119], v[88:91], v[60:63]
    v_mfma_f32_16x16x32_bf16 v[60:63], a[124:127], v[92:95], v[60:63]
    s_waitcnt lgkmcnt(1)
    v_mfma_f32_16x16x32_bf16 v[64:67], a[0:3], v[108:111], 0
    v_mul_f32 v124, v0, v0
    v_mul_f32 v125, v1, v1
    v_mfma_f32_16x16x32_bf16 v[64:67], a[8:11], v[112:115], v[64:67]
    v_fma_f32 v124, v124, s64, v123
    v_fma_f32 v125, v125, s64, v123
    v_mul_f32 v124, v124, v0
    v_mfma_f32_16x16x32_bf16 v[72:75], a[4:7], v[108:111], 0
    ds_read_b128 v[108:111], v119 offset:4096
    v_mul_f32 v125, v125, v1
    v_exp_f32 v124, v124
    v_mfma_f32_16x16x32_bf16 v[72:75], a[12:15], v[112:115], v[72:75]
    ds_read_b128 v[112:115], v118 offset:6144
    v_exp_f32 v125, v125
    v_mfma_f32_16x16x32_bf16 v[68:71], a[0:3], v[96:99], 0
    v_mul_f32 v8, v0, v8
    v_mul_f32 v9, v1, v9
    v_mfma_f32_16x16x32_bf16 v[68:71], a[8:11], v[100:103], v[68:71]
    v_add_f32 v124, 1.0, v124
    v_add_f32 v125, 1.0, v125
    v_rcp_f32 v124, v124
    v_mfma_f32_16x16x32_bf16 v[76:79], a[4:7], v[96:99], 0
    ds_read_b128 v[96:99], v119 offset:6144
    v_rcp_f32 v125, v125
    v_mfma_f32_16x16x32_bf16 v[76:79], a[12:15], v[100:103], v[76:79]
    ds_read_b128 v[100:103], v118 offset:8192
    v_mul_f32 v8, v8, v124
    v_mul_f32 v9, v9, v125
    s_waitcnt lgkmcnt(2)
    v_mfma_f32_16x16x32_bf16 v[80:83], a[0:3], v[104:107], 0
    v_cvt_pk_bf16_f32 v0, v8, v9
    v_mul_f32 v126, v2, v2
    v_mfma_f32_16x16x32_bf16 v[80:83], a[8:11], v[108:111], v[80:83]
    v_mul_f32 v127, v3, v3
    v_fma_f32 v126, v126, s64, v123
    v_fma_f32 v127, v127, s64, v123
    v_mfma_f32_16x16x32_bf16 v[88:91], a[4:7], v[104:107], 0
    ds_read_b128 v[104:107], v119 offset:8192
    v_mul_f32 v126, v126, v2
    v_mul_f32 v127, v127, v3
    v_mfma_f32_16x16x32_bf16 v[88:91], a[12:15], v[108:111], v[88:91]
    ds_read_b128 v[108:111], v118 offset:10240
    v_exp_f32 v126, v126
    v_exp_f32 v127, v127
    v_mfma_f32_16x16x32_bf16 v[84:87], a[0:3], v[112:115], 0
    v_mul_f32 v10, v2, v10
    v_mul_f32 v11, v3, v11
    s_waitcnt lgkmcnt(2)
    v_mfma_f32_16x16x32_bf16 v[84:87], a[8:11], v[96:99], v[84:87]
    v_add_f32 v126, 1.0, v126
    v_add_f32 v127, 1.0, v127
    v_mfma_f32_16x16x32_bf16 v[92:95], a[4:7], v[112:115], 0
    ds_read_b128 v[112:115], v119 offset:10240
    v_rcp_f32 v126, v126
    v_mfma_f32_16x16x32_bf16 v[92:95], a[12:15], v[96:99], v[92:95]
    ds_read_b128 v[96:99], v118 offset:12288
    v_rcp_f32 v127, v127
    v_mul_f32 v10, v10, v126
    v_mfma_f32_16x16x32_bf16 v[64:67], a[16:19], v[100:103], v[64:67]
    v_mul_f32 v11, v11, v127
    v_cvt_pk_bf16_f32 v1, v10, v11
    s_waitcnt lgkmcnt(2)
    v_mfma_f32_16x16x32_bf16 v[64:67], a[24:27], v[104:107], v[64:67]
    v_mul_f32 v124, v4, v4
    v_mul_f32 v125, v5, v5
    v_fma_f32 v124, v124, s64, v123
    v_mfma_f32_16x16x32_bf16 v[72:75], a[20:23], v[100:103], v[72:75]
    ds_read_b128 v[100:103], v119 offset:12288
    v_fma_f32 v125, v125, s64, v123
    v_mul_f32 v124, v124, v4
    v_mfma_f32_16x16x32_bf16 v[72:75], a[28:31], v[104:107], v[72:75]
    ds_read_b128 v[104:107], v118 offset:14336
    v_mul_f32 v125, v125, v5
    v_exp_f32 v124, v124
    v_mfma_f32_16x16x32_bf16 v[68:71], a[16:19], v[108:111], v[68:71]
    v_exp_f32 v125, v125
    s_waitcnt lgkmcnt(2)
    v_mfma_f32_16x16x32_bf16 v[68:71], a[24:27], v[112:115], v[68:71]
    v_mul_f32 v12, v4, v12
    v_mul_f32 v13, v5, v13
    v_add_f32 v124, 1.0, v124
    v_mfma_f32_16x16x32_bf16 v[76:79], a[20:23], v[108:111], v[76:79]
    ds_read_b128 v[108:111], v119 offset:14336
    v_add_f32 v125, 1.0, v125
    v_rcp_f32 v124, v124
    v_mfma_f32_16x16x32_bf16 v[76:79], a[28:31], v[112:115], v[76:79]
    ds_read_b128 v[112:115], v118 offset:16384
    v_rcp_f32 v125, v125
    v_mfma_f32_16x16x32_bf16 v[80:83], a[16:19], v[96:99], v[80:83]
    v_mul_f32 v12, v12, v124
    v_mul_f32 v13, v13, v125
    s_waitcnt lgkmcnt(2)
    v_mfma_f32_16x16x32_bf16 v[80:83], a[24:27], v[100:103], v[80:83]
    v_cvt_pk_bf16_f32 v2, v12, v13
    v_mul_f32 v126, v6, v6
    v_mul_f32 v127, v7, v7
    v_mfma_f32_16x16x32_bf16 v[88:91], a[20:23], v[96:99], v[88:91]
    ds_read_b128 v[96:99], v119 offset:16384
    v_fma_f32 v126, v126, s64, v123
    v_fma_f32 v127, v127, s64, v123
    v_mfma_f32_16x16x32_bf16 v[88:91], a[28:31], v[100:103], v[88:91]
    ds_read_b128 v[100:103], v118 offset:18432
    v_mul_f32 v126, v126, v6
    v_mul_f32 v127, v127, v7
    v_exp_f32 v126, v126
    v_mfma_f32_16x16x32_bf16 v[84:87], a[16:19], v[104:107], v[84:87]
    v_exp_f32 v127, v127
    s_waitcnt lgkmcnt(2)
    v_mfma_f32_16x16x32_bf16 v[84:87], a[24:27], v[108:111], v[84:87]
    v_mul_f32 v14, v6, v14
    v_mul_f32 v15, v7, v15
    v_mfma_f32_16x16x32_bf16 v[92:95], a[20:23], v[104:107], v[92:95]
    ds_read_b128 v[104:107], v119 offset:18432
    v_add_f32 v126, 1.0, v126
    v_add_f32 v127, 1.0, v127
    v_mfma_f32_16x16x32_bf16 v[92:95], a[28:31], v[108:111], v[92:95]
    ds_read_b128 v[108:111], v118 offset:20480
    v_rcp_f32 v126, v126
    v_rcp_f32 v127, v127
    v_mfma_f32_16x16x32_bf16 v[64:67], a[32:35], v[112:115], v[64:67]
    v_mul_f32 v14, v14, v126
    v_mul_f32 v15, v15, v127
    s_waitcnt lgkmcnt(2)
    v_mfma_f32_16x16x32_bf16 v[64:67], a[40:43], v[96:99], v[64:67]
    v_cvt_pk_bf16_f32 v3, v14, v15
    s_add_u32 s58, s62, 0
    v_mfma_f32_16x16x32_bf16 v[72:75], a[36:39], v[112:115], v[72:75]
    ds_read_b128 v[112:115], v119 offset:20480
    v_permlane16_swap_b32 v0, v2
    v_permlane16_swap_b32 v1, v3
    v_mfma_f32_16x16x32_bf16 v[72:75], a[44:47], v[96:99], v[72:75]
    ds_read_b128 v[96:99], v118 offset:22528
    buffer_store_dwordx4 v[0:3], v122, s[36:39], s58 offen sc1
    v_mul_f32 v124, v16, v16
    v_mul_f32 v125, v17, v17
    v_mfma_f32_16x16x32_bf16 v[68:71], a[32:35], v[100:103], v[68:71]
    v_fma_f32 v124, v124, s64, v123
    v_fma_f32 v125, v125, s64, v123
    s_waitcnt lgkmcnt(2)
    v_mfma_f32_16x16x32_bf16 v[68:71], a[40:43], v[104:107], v[68:71]
    v_mul_f32 v124, v124, v16
    v_mul_f32 v125, v125, v17
    v_exp_f32 v124, v124
    v_mfma_f32_16x16x32_bf16 v[76:79], a[36:39], v[100:103], v[76:79]
    ds_read_b128 v[100:103], v119 offset:22528
    v_exp_f32 v125, v125
    v_mfma_f32_16x16x32_bf16 v[76:79], a[44:47], v[104:107], v[76:79]
    ds_read_b128 v[104:107], v118 offset:24576
    v_mul_f32 v24, v16, v24
    v_mul_f32 v25, v17, v25
    v_mfma_f32_16x16x32_bf16 v[80:83], a[32:35], v[108:111], v[80:83]
    v_add_f32 v124, 1.0, v124
    v_add_f32 v125, 1.0, v125
    s_waitcnt lgkmcnt(2)
    v_mfma_f32_16x16x32_bf16 v[80:83], a[40:43], v[112:115], v[80:83]
    v_rcp_f32 v124, v124
    v_rcp_f32 v125, v125
    v_mfma_f32_16x16x32_bf16 v[88:91], a[36:39], v[108:111], v[88:91]
    ds_read_b128 v[108:111], v119 offset:24576
    v_mul_f32 v24, v24, v124
    v_mfma_f32_16x16x32_bf16 v[88:91], a[44:47], v[112:115], v[88:91]
    ds_read_b128 v[112:115], v118 offset:26624
    v_mul_f32 v25, v25, v125
    v_cvt_pk_bf16_f32 v16, v24, v25
    v_mul_f32 v126, v18, v18
    v_mfma_f32_16x16x32_bf16 v[84:87], a[32:35], v[96:99], v[84:87]
    v_mul_f32 v127, v19, v19
    v_fma_f32 v126, v126, s64, v123
    s_waitcnt lgkmcnt(2)
    v_mfma_f32_16x16x32_bf16 v[84:87], a[40:43], v[100:103], v[84:87]
    v_fma_f32 v127, v127, s64, v123
    v_mul_f32 v126, v126, v18
    v_mul_f32 v127, v127, v19
    v_mfma_f32_16x16x32_bf16 v[92:95], a[36:39], v[96:99], v[92:95]
    ds_read_b128 v[96:99], v119 offset:26624
    v_exp_f32 v126, v126
    v_mfma_f32_16x16x32_bf16 v[92:95], a[44:47], v[100:103], v[92:95]
    ds_read_b128 v[100:103], v118 offset:28672
    v_exp_f32 v127, v127
    v_mul_f32 v26, v18, v26
    v_mfma_f32_16x16x32_bf16 v[64:67], a[48:51], v[104:107], v[64:67]
    v_mul_f32 v27, v19, v27
    v_add_f32 v126, 1.0, v126
    s_waitcnt lgkmcnt(2)
    v_mfma_f32_16x16x32_bf16 v[64:67], a[56:59], v[108:111], v[64:67]
    v_add_f32 v127, 1.0, v127
    v_rcp_f32 v126, v126
    v_mfma_f32_16x16x32_bf16 v[72:75], a[52:55], v[104:107], v[72:75]
    ds_read_b128 v[104:107], v119 offset:28672
    v_rcp_f32 v127, v127
    v_mfma_f32_16x16x32_bf16 v[72:75], a[60:63], v[108:111], v[72:75]
    ds_read_b128 v[108:111], v118 offset:30720
    v_mul_f32 v26, v26, v126
    v_mul_f32 v27, v27, v127
    v_cvt_pk_bf16_f32 v17, v26, v27
    v_mfma_f32_16x16x32_bf16 v[68:71], a[48:51], v[112:115], v[68:71]
    v_mul_f32 v124, v20, v20
    v_mul_f32 v125, v21, v21
    s_waitcnt lgkmcnt(2)
    v_mfma_f32_16x16x32_bf16 v[68:71], a[56:59], v[96:99], v[68:71]
    v_fma_f32 v124, v124, s64, v123
    v_fma_f32 v125, v125, s64, v123
    v_mul_f32 v124, v124, v20
    v_mfma_f32_16x16x32_bf16 v[76:79], a[52:55], v[112:115], v[76:79]
    ds_read_b128 v[112:115], v119 offset:30720
    v_mul_f32 v125, v125, v21
    v_exp_f32 v124, v124
    v_mfma_f32_16x16x32_bf16 v[76:79], a[60:63], v[96:99], v[76:79]
    v_exp_f32 v125, v125
    v_mfma_f32_16x16x32_bf16 v[80:83], a[48:51], v[100:103], v[80:83]
    v_mul_f32 v28, v20, v28
    v_mul_f32 v29, v21, v29
    s_waitcnt lgkmcnt(1)
    v_mfma_f32_16x16x32_bf16 v[80:83], a[56:59], v[104:107], v[80:83]
    v_add_f32 v124, 1.0, v124
    v_add_f32 v125, 1.0, v125
    v_rcp_f32 v124, v124
    v_mfma_f32_16x16x32_bf16 v[88:91], a[52:55], v[100:103], v[88:91]
    s_waitcnt lgkmcnt(0)
    s_barrier
    ds_read_b128 v[96:99], v116 offset:0
    v_rcp_f32 v125, v125
    v_mfma_f32_16x16x32_bf16 v[88:91], a[60:63], v[104:107], v[88:91]
    ds_read_b128 v[100:103], v117 offset:0
    v_mul_f32 v28, v28, v124
    v_mul_f32 v29, v29, v125
    v_mfma_f32_16x16x32_bf16 v[84:87], a[48:51], v[108:111], v[84:87]
    ds_read_b128 v[104:107], v116 offset:2048
    v_cvt_pk_bf16_f32 v18, v28, v29
    v_mul_f32 v126, v22, v22
    v_mfma_f32_16x16x32_bf16 v[84:87], a[56:59], v[112:115], v[84:87]
    v_mul_f32 v127, v23, v23
    v_fma_f32 v126, v126, s64, v123
    v_fma_f32 v127, v127, s64, v123
    v_mfma_f32_16x16x32_bf16 v[92:95], a[52:55], v[108:111], v[92:95]
    ds_read_b128 v[108:111], v117 offset:2048
    v_mul_f32 v126, v126, v22
    v_mul_f32 v127, v127, v23
    v_mfma_f32_16x16x32_bf16 v[92:95], a[60:63], v[112:115], v[92:95]
    ds_read_b128 v[112:115], v116 offset:4096
    v_exp_f32 v126, v126
    v_exp_f32 v127, v127
    s_waitcnt lgkmcnt(2)
    v_mfma_f32_16x16x32_bf16 v[64:67], a[64:67], v[96:99], v[64:67]
    v_mul_f32 v30, v22, v30
    v_mul_f32 v31, v23, v31
    v_mfma_f32_16x16x32_bf16 v[64:67], a[72:75], v[100:103], v[64:67]
    v_add_f32 v126, 1.0, v126
    v_add_f32 v127, 1.0, v127
    v_mfma_f32_16x16x32_bf16 v[72:75], a[68:71], v[96:99], v[72:75]
    ds_read_b128 v[96:99], v117 offset:4096
    v_rcp_f32 v126, v126
    v_mfma_f32_16x16x32_bf16 v[72:75], a[76:79], v[100:103], v[72:75]
    ds_read_b128 v[100:103], v116 offset:6144
    v_rcp_f32 v127, v127
    v_mul_f32 v30, v30, v126
    v_mfma_f32_16x16x32_bf16 v[68:71], a[64:67], v[104:107], v[68:71]
    v_mul_f32 v31, v31, v127
    v_cvt_pk_bf16_f32 v19, v30, v31
    s_waitcnt lgkmcnt(2)
    v_mfma_f32_16x16x32_bf16 v[68:71], a[72:75], v[108:111], v[68:71]
    s_add_u32 s58, s62, 114688
    v_permlane16_swap_b32 v16, v18
    v_permlane16_swap_b32 v17, v19
    v_mfma_f32_16x16x32_bf16 v[76:79], a[68:71], v[104:107], v[76:79]
    ds_read_b128 v[104:107], v117 offset:6144
    buffer_store_dwordx4 v[16:19], v122, s[36:39], s58 offen sc1
    v_mul_f32 v124, v32, v32
    v_mfma_f32_16x16x32_bf16 v[76:79], a[76:79], v[108:111], v[76:79]
    ds_read_b128 v[108:111], v116 offset:8192
    v_mul_f32 v125, v33, v33
    v_fma_f32 v124, v124, s64, v123
    v_fma_f32 v125, v125, s64, v123
    v_mfma_f32_16x16x32_bf16 v[80:83], a[64:67], v[112:115], v[80:83]
    v_mul_f32 v124, v124, v32
    v_mul_f32 v125, v125, v33
    s_waitcnt lgkmcnt(2)
    v_mfma_f32_16x16x32_bf16 v[80:83], a[72:75], v[96:99], v[80:83]
    v_exp_f32 v124, v124
    v_exp_f32 v125, v125
    v_mfma_f32_16x16x32_bf16 v[88:91], a[68:71], v[112:115], v[88:91]
    ds_read_b128 v[112:115], v117 offset:8192
    v_mul_f32 v40, v32, v40
    v_mfma_f32_16x16x32_bf16 v[88:91], a[76:79], v[96:99], v[88:91]
    ds_read_b128 v[96:99], v116 offset:10240
    v_mul_f32 v41, v33, v41
    v_add_f32 v124, 1.0, v124
    v_add_f32 v125, 1.0, v125
    v_mfma_f32_16x16x32_bf16 v[84:87], a[64:67], v[100:103], v[84:87]
    v_rcp_f32 v124, v124
    s_waitcnt lgkmcnt(2)
    v_mfma_f32_16x16x32_bf16 v[84:87], a[72:75], v[104:107], v[84:87]
    v_rcp_f32 v125, v125
    v_mul_f32 v40, v40, v124
    v_mfma_f32_16x16x32_bf16 v[92:95], a[68:71], v[100:103], v[92:95]
    ds_read_b128 v[100:103], v117 offset:10240
    v_mul_f32 v41, v41, v125
    v_cvt_pk_bf16_f32 v32, v40, v41
    v_mfma_f32_16x16x32_bf16 v[92:95], a[76:79], v[104:107], v[92:95]
    ds_read_b128 v[104:107], v116 offset:12288
    v_mul_f32 v126, v34, v34
    v_mul_f32 v127, v35, v35
    v_fma_f32 v126, v126, s64, v123
    v_mfma_f32_16x16x32_bf16 v[64:67], a[80:83], v[108:111], v[64:67]
    v_fma_f32 v127, v127, s64, v123
    v_mul_f32 v126, v126, v34
    s_waitcnt lgkmcnt(2)
    v_mfma_f32_16x16x32_bf16 v[64:67], a[88:91], v[112:115], v[64:67]
    v_mul_f32 v127, v127, v35
    v_exp_f32 v126, v126
    v_mfma_f32_16x16x32_bf16 v[72:75], a[84:87], v[108:111], v[72:75]
    ds_read_b128 v[108:111], v117 offset:12288
    v_exp_f32 v127, v127
    v_mfma_f32_16x16x32_bf16 v[72:75], a[92:95], v[112:115], v[72:75]
    ds_read_b128 v[112:115], v116 offset:14336
    v_mul_f32 v42, v34, v42
    v_mul_f32 v43, v35, v43
    v_add_f32 v126, 1.0, v126
    v_mfma_f32_16x16x32_bf16 v[68:71], a[80:83], v[96:99], v[68:71]
    v_add_f32 v127, 1.0, v127
    v_rcp_f32 v126, v126
    s_waitcnt lgkmcnt(2)
    v_mfma_f32_16x16x32_bf16 v[68:71], a[88:91], v[100:103], v[68:71]
    v_rcp_f32 v127, v127
    v_mfma_f32_16x16x32_bf16 v[76:79], a[84:87], v[96:99], v[76:79]
    ds_read_b128 v[96:99], v117 offset:14336
    v_mul_f32 v42, v42, v126
    v_mul_f32 v43, v43, v127
    v_mfma_f32_16x16x32_bf16 v[76:79], a[92:95], v[100:103], v[76:79]
    ds_read_b128 v[100:103], v116 offset:16384
    v_cvt_pk_bf16_f32 v33, v42, v43
    v_mul_f32 v124, v36, v36
    v_mul_f32 v125, v37, v37
    v_mfma_f32_16x16x32_bf16 v[80:83], a[80:83], v[104:107], v[80:83]
    v_fma_f32 v124, v124, s64, v123
    v_fma_f32 v125, v125, s64, v123
    s_waitcnt lgkmcnt(2)
    v_mfma_f32_16x16x32_bf16 v[80:83], a[88:91], v[108:111], v[80:83]
    v_mul_f32 v124, v124, v36
    v_mul_f32 v125, v125, v37
    v_exp_f32 v124, v124
    v_mfma_f32_16x16x32_bf16 v[88:91], a[84:87], v[104:107], v[88:91]
    ds_read_b128 v[104:107], v117 offset:16384
    v_exp_f32 v125, v125
    v_mfma_f32_16x16x32_bf16 v[88:91], a[92:95], v[108:111], v[88:91]
    ds_read_b128 v[108:111], v116 offset:18432
    v_mul_f32 v44, v36, v44
    v_mul_f32 v45, v37, v45
    v_mfma_f32_16x16x32_bf16 v[84:87], a[80:83], v[112:115], v[84:87]
    v_add_f32 v124, 1.0, v124
    v_add_f32 v125, 1.0, v125
    s_waitcnt lgkmcnt(2)
    v_mfma_f32_16x16x32_bf16 v[84:87], a[88:91], v[96:99], v[84:87]
    v_rcp_f32 v124, v124
    v_rcp_f32 v125, v125
    v_mfma_f32_16x16x32_bf16 v[92:95], a[84:87], v[112:115], v[92:95]
    ds_read_b128 v[112:115], v117 offset:18432
    v_mul_f32 v44, v44, v124
    v_mfma_f32_16x16x32_bf16 v[92:95], a[92:95], v[96:99], v[92:95]
    ds_read_b128 v[96:99], v116 offset:20480
    v_mul_f32 v45, v45, v125
    v_cvt_pk_bf16_f32 v34, v44, v45
    v_mul_f32 v126, v38, v38
    v_mfma_f32_16x16x32_bf16 v[64:67], a[96:99], v[100:103], v[64:67]
    v_mul_f32 v127, v39, v39
    v_fma_f32 v126, v126, s64, v123
    s_waitcnt lgkmcnt(2)
    v_mfma_f32_16x16x32_bf16 v[64:67], a[104:107], v[104:107], v[64:67]
    v_fma_f32 v127, v127, s64, v123
    v_mul_f32 v126, v126, v38
    v_mul_f32 v127, v127, v39
    v_mfma_f32_16x16x32_bf16 v[72:75], a[100:103], v[100:103], v[72:75]
    ds_read_b128 v[100:103], v117 offset:20480
    v_exp_f32 v126, v126
    v_mfma_f32_16x16x32_bf16 v[72:75], a[108:111], v[104:107], v[72:75]
    ds_read_b128 v[104:107], v116 offset:22528
    v_exp_f32 v127, v127
    v_mul_f32 v46, v38, v46
    v_mfma_f32_16x16x32_bf16 v[68:71], a[96:99], v[108:111], v[68:71]
    v_mul_f32 v47, v39, v47
    v_add_f32 v126, 1.0, v126
    s_waitcnt lgkmcnt(2)
    v_mfma_f32_16x16x32_bf16 v[68:71], a[104:107], v[112:115], v[68:71]
    v_add_f32 v127, 1.0, v127
    v_rcp_f32 v126, v126
    v_mfma_f32_16x16x32_bf16 v[76:79], a[100:103], v[108:111], v[76:79]
    ds_read_b128 v[108:111], v117 offset:22528
    v_rcp_f32 v127, v127
    v_mfma_f32_16x16x32_bf16 v[76:79], a[108:111], v[112:115], v[76:79]
    ds_read_b128 v[112:115], v116 offset:24576
    v_mul_f32 v46, v46, v126
    v_mul_f32 v47, v47, v127
    v_cvt_pk_bf16_f32 v35, v46, v47
    v_mfma_f32_16x16x32_bf16 v[80:83], a[96:99], v[96:99], v[80:83]
    s_add_u32 s58, s62, 229376
    v_permlane16_swap_b32 v32, v34
    s_waitcnt lgkmcnt(2)
    v_mfma_f32_16x16x32_bf16 v[80:83], a[104:107], v[100:103], v[80:83]
    v_permlane16_swap_b32 v33, v35
    buffer_store_dwordx4 v[32:35], v122, s[36:39], s58 offen sc1
    v_mul_f32 v124, v48, v48
    v_mfma_f32_16x16x32_bf16 v[88:91], a[100:103], v[96:99], v[88:91]
    ds_read_b128 v[96:99], v117 offset:24576
    v_mul_f32 v125, v49, v49
    v_fma_f32 v124, v124, s64, v123
    v_mfma_f32_16x16x32_bf16 v[88:91], a[108:111], v[100:103], v[88:91]
    ds_read_b128 v[100:103], v116 offset:26624
    v_fma_f32 v125, v125, s64, v123
    v_mul_f32 v124, v124, v48
    v_mul_f32 v125, v125, v49
    v_mfma_f32_16x16x32_bf16 v[84:87], a[96:99], v[104:107], v[84:87]
    v_exp_f32 v124, v124
    s_waitcnt lgkmcnt(2)
    v_mfma_f32_16x16x32_bf16 v[84:87], a[104:107], v[108:111], v[84:87]
    v_exp_f32 v125, v125
    v_mul_f32 v56, v48, v56
    v_mfma_f32_16x16x32_bf16 v[92:95], a[100:103], v[104:107], v[92:95]
    ds_read_b128 v[104:107], v117 offset:26624
    v_mul_f32 v57, v49, v57
    v_add_f32 v124, 1.0, v124
    v_mfma_f32_16x16x32_bf16 v[92:95], a[108:111], v[108:111], v[92:95]
    ds_read_b128 v[108:111], v116 offset:28672
    v_add_f32 v125, 1.0, v125
    v_rcp_f32 v124, v124
    v_mfma_f32_16x16x32_bf16 v[64:67], a[112:115], v[112:115], v[64:67]
    v_rcp_f32 v125, v125
    s_waitcnt lgkmcnt(2)
    v_mfma_f32_16x16x32_bf16 v[64:67], a[120:123], v[96:99], v[64:67]
    v_mul_f32 v56, v56, v124
    v_mul_f32 v57, v57, v125
    v_cvt_pk_bf16_f32 v48, v56, v57
    v_mfma_f32_16x16x32_bf16 v[72:75], a[116:119], v[112:115], v[72:75]
    ds_read_b128 v[112:115], v117 offset:28672
    v_mul_f32 v126, v50, v50
    v_mul_f32 v127, v51, v51
    v_mfma_f32_16x16x32_bf16 v[72:75], a[124:127], v[96:99], v[72:75]
    ds_read_b128 v[96:99], v116 offset:30720
    v_fma_f32 v126, v126, s64, v123
    v_fma_f32 v127, v127, s64, v123
    v_mul_f32 v126, v126, v50
    v_mfma_f32_16x16x32_bf16 v[68:71], a[112:115], v[100:103], v[68:71]
    v_mul_f32 v127, v127, v51
    v_exp_f32 v126, v126
    s_waitcnt lgkmcnt(2)
    v_mfma_f32_16x16x32_bf16 v[68:71], a[120:123], v[104:107], v[68:71]
    v_exp_f32 v127, v127
    v_mfma_f32_16x16x32_bf16 v[76:79], a[116:119], v[100:103], v[76:79]
    ds_read_b128 v[100:103], v117 offset:30720
    v_mul_f32 v58, v50, v58
    v_mul_f32 v59, v51, v59
    v_mfma_f32_16x16x32_bf16 v[76:79], a[124:127], v[104:107], v[76:79]
    ds_read_b128 v[104:107], v116 offset:32768
    v_add_f32 v126, 1.0, v126
    v_add_f32 v127, 1.0, v127
    v_rcp_f32 v126, v126
    v_mfma_f32_16x16x32_bf16 v[80:83], a[112:115], v[108:111], v[80:83]
    v_rcp_f32 v127, v127
    s_waitcnt lgkmcnt(2)
    v_mfma_f32_16x16x32_bf16 v[80:83], a[120:123], v[112:115], v[80:83]
    v_mul_f32 v58, v58, v126
    v_mul_f32 v59, v59, v127
    v_mfma_f32_16x16x32_bf16 v[88:91], a[116:119], v[108:111], v[88:91]
    ds_read_b128 v[108:111], v117 offset:32768
    v_cvt_pk_bf16_f32 v49, v58, v59
    v_mul_f32 v124, v52, v52
    v_mfma_f32_16x16x32_bf16 v[88:91], a[124:127], v[112:115], v[88:91]
    ds_read_b128 v[112:115], v116 offset:34816
    v_mul_f32 v125, v53, v53
    v_fma_f32 v124, v124, s64, v123
    v_fma_f32 v125, v125, s64, v123
    v_mfma_f32_16x16x32_bf16 v[84:87], a[112:115], v[96:99], v[84:87]
    v_mul_f32 v124, v124, v52
    v_mul_f32 v125, v125, v53
    s_waitcnt lgkmcnt(2)
    v_mfma_f32_16x16x32_bf16 v[84:87], a[120:123], v[100:103], v[84:87]
    v_exp_f32 v124, v124
    v_exp_f32 v125, v125
    v_mfma_f32_16x16x32_bf16 v[92:95], a[116:119], v[96:99], v[92:95]
    ds_read_b128 v[96:99], v117 offset:34816
    v_mul_f32 v60, v52, v60
    v_mfma_f32_16x16x32_bf16 v[92:95], a[124:127], v[100:103], v[92:95]
    ds_read_b128 v[100:103], v116 offset:36864
    v_mul_f32 v61, v53, v61
    v_add_f32 v124, 1.0, v124
    v_add_f32 v125, 1.0, v125
    v_mfma_f32_16x16x32_bf16 v[0:3], a[0:3], v[104:107], 0
    v_rcp_f32 v124, v124
    s_waitcnt lgkmcnt(2)
    v_mfma_f32_16x16x32_bf16 v[0:3], a[8:11], v[108:111], v[0:3]
    v_rcp_f32 v125, v125
    v_mul_f32 v60, v60, v124
    v_mfma_f32_16x16x32_bf16 v[8:11], a[4:7], v[104:107], 0
    ds_read_b128 v[104:107], v117 offset:36864
    v_mul_f32 v61, v61, v125
    v_cvt_pk_bf16_f32 v50, v60, v61
    v_mfma_f32_16x16x32_bf16 v[8:11], a[12:15], v[108:111], v[8:11]
    ds_read_b128 v[108:111], v116 offset:38912
    v_mul_f32 v126, v54, v54
    v_mul_f32 v127, v55, v55
    v_fma_f32 v126, v126, s64, v123
    s_waitcnt vmcnt(1)
    s_add_u32 s15, s63, 0
    s_atomic_add s14, s[36:37], s15
    v_mfma_f32_16x16x32_bf16 v[4:7], a[0:3], v[112:115], 0
    v_fma_f32 v127, v127, s64, v123
    v_mul_f32 v126, v126, v54
    s_waitcnt lgkmcnt(2)
    v_mfma_f32_16x16x32_bf16 v[4:7], a[8:11], v[96:99], v[4:7]
    v_mul_f32 v127, v127, v55
    v_exp_f32 v126, v126
    v_mfma_f32_16x16x32_bf16 v[12:15], a[4:7], v[112:115], 0
    ds_read_b128 v[112:115], v117 offset:38912
    v_exp_f32 v127, v127
    v_mfma_f32_16x16x32_bf16 v[12:15], a[12:15], v[96:99], v[12:15]
    ds_read_b128 v[96:99], v116 offset:40960
    v_mul_f32 v62, v54, v62
    v_mul_f32 v63, v55, v63
    v_add_f32 v126, 1.0, v126
    v_mfma_f32_16x16x32_bf16 v[16:19], a[0:3], v[100:103], 0
    v_add_f32 v127, 1.0, v127
    v_rcp_f32 v126, v126
    s_waitcnt lgkmcnt(2)
    v_mfma_f32_16x16x32_bf16 v[16:19], a[8:11], v[104:107], v[16:19]
    v_rcp_f32 v127, v127
    v_mfma_f32_16x16x32_bf16 v[24:27], a[4:7], v[100:103], 0
    ds_read_b128 v[100:103], v117 offset:40960
    v_mul_f32 v62, v62, v126
    v_mul_f32 v63, v63, v127
    v_mfma_f32_16x16x32_bf16 v[24:27], a[12:15], v[104:107], v[24:27]
    ds_read_b128 v[104:107], v116 offset:43008
    v_cvt_pk_bf16_f32 v51, v62, v63
    s_add_u32 s58, s62, 344064
    v_permlane16_swap_b32 v48, v50
    v_mfma_f32_16x16x32_bf16 v[20:23], a[0:3], v[108:111], 0
    v_permlane16_swap_b32 v49, v51
    buffer_store_dwordx4 v[48:51], v122, s[36:39], s58 offen sc1
    s_waitcnt lgkmcnt(2)
    v_mfma_f32_16x16x32_bf16 v[20:23], a[8:11], v[112:115], v[20:23]
    v_mul_f32 v124, v64, v64
    v_mul_f32 v125, v65, v65
    v_fma_f32 v124, v124, s64, v123
    v_mfma_f32_16x16x32_bf16 v[28:31], a[4:7], v[108:111], 0
    ds_read_b128 v[108:111], v117 offset:43008
    v_fma_f32 v125, v125, s64, v123
    v_mul_f32 v124, v124, v64
    v_mfma_f32_16x16x32_bf16 v[28:31], a[12:15], v[112:115], v[28:31]
    ds_read_b128 v[112:115], v116 offset:45056
    v_mul_f32 v125, v125, v65
    v_exp_f32 v124, v124
    v_mfma_f32_16x16x32_bf16 v[0:3], a[16:19], v[96:99], v[0:3]
    v_exp_f32 v125, v125
    s_waitcnt lgkmcnt(2)
    v_mfma_f32_16x16x32_bf16 v[0:3], a[24:27], v[100:103], v[0:3]
    v_mul_f32 v72, v64, v72
    v_mul_f32 v73, v65, v73
    v_add_f32 v124, 1.0, v124
    v_mfma_f32_16x16x32_bf16 v[8:11], a[20:23], v[96:99], v[8:11]
    ds_read_b128 v[96:99], v117 offset:45056
    v_add_f32 v125, 1.0, v125
    v_rcp_f32 v124, v124
    v_mfma_f32_16x16x32_bf16 v[8:11], a[28:31], v[100:103], v[8:11]
    ds_read_b128 v[100:103], v116 offset:47104
    v_rcp_f32 v125, v125
    v_mfma_f32_16x16x32_bf16 v[4:7], a[16:19], v[104:107], v[4:7]
    v_mul_f32 v72, v72, v124
    v_mul_f32 v73, v73, v125
    s_waitcnt lgkmcnt(2)
    v_mfma_f32_16x16x32_bf16 v[4:7], a[24:27], v[108:111], v[4:7]
    v_cvt_pk_bf16_f32 v64, v72, v73
    v_mul_f32 v126, v66, v66
    v_mul_f32 v127, v67, v67
    v_mfma_f32_16x16x32_bf16 v[12:15], a[20:23], v[104:107], v[12:15]
    ds_read_b128 v[104:107], v117 offset:47104
    v_fma_f32 v126, v126, s64, v123
    v_fma_f32 v127, v127, s64, v123
    v_mfma_f32_16x16x32_bf16 v[12:15], a[28:31], v[108:111], v[12:15]
    ds_read_b128 v[108:111], v116 offset:49152
    v_mul_f32 v126, v126, v66
    v_mul_f32 v127, v127, v67
    v_exp_f32 v126, v126
    v_mfma_f32_16x16x32_bf16 v[16:19], a[16:19], v[112:115], v[16:19]
    v_exp_f32 v127, v127
    s_waitcnt lgkmcnt(2)
    v_mfma_f32_16x16x32_bf16 v[16:19], a[24:27], v[96:99], v[16:19]
    v_mul_f32 v74, v66, v74
    v_mul_f32 v75, v67, v75
    v_mfma_f32_16x16x32_bf16 v[24:27], a[20:23], v[112:115], v[24:27]
    ds_read_b128 v[112:115], v117 offset:49152
    v_add_f32 v126, 1.0, v126
    v_add_f32 v127, 1.0, v127
    v_mfma_f32_16x16x32_bf16 v[24:27], a[28:31], v[96:99], v[24:27]
    ds_read_b128 v[96:99], v116 offset:51200
    v_rcp_f32 v126, v126
    v_rcp_f32 v127, v127
    v_mfma_f32_16x16x32_bf16 v[20:23], a[16:19], v[100:103], v[20:23]
    v_mul_f32 v74, v74, v126
    v_mul_f32 v75, v75, v127
    s_waitcnt lgkmcnt(2)
    v_mfma_f32_16x16x32_bf16 v[20:23], a[24:27], v[104:107], v[20:23]
    v_cvt_pk_bf16_f32 v65, v74, v75
    v_mul_f32 v124, v68, v68
    v_mfma_f32_16x16x32_bf16 v[28:31], a[20:23], v[100:103], v[28:31]
    ds_read_b128 v[100:103], v117 offset:51200
    v_mul_f32 v125, v69, v69
    v_fma_f32 v124, v124, s64, v123
    v_mfma_f32_16x16x32_bf16 v[28:31], a[28:31], v[104:107], v[28:31]
    ds_read_b128 v[104:107], v116 offset:53248
    v_fma_f32 v125, v125, s64, v123
    v_mul_f32 v124, v124, v68
    v_mul_f32 v125, v125, v69
    v_mfma_f32_16x16x32_bf16 v[0:3], a[32:35], v[108:111], v[0:3]
    v_exp_f32 v124, v124
    s_waitcnt lgkmcnt(2)
    v_mfma_f32_16x16x32_bf16 v[0:3], a[40:43], v[112:115], v[0:3]
    v_exp_f32 v125, v125
    v_mul_f32 v76, v68, v76
    v_mfma_f32_16x16x32_bf16 v[8:11], a[36:39], v[108:111], v[8:11]
    ds_read_b128 v[108:111], v117 offset:53248
    v_mul_f32 v77, v69, v77
    v_add_f32 v124, 1.0, v124
    v_mfma_f32_16x16x32_bf16 v[8:11], a[44:47], v[112:115], v[8:11]
    ds_read_b128 v[112:115], v116 offset:55296
    v_add_f32 v125, 1.0, v125
    v_rcp_f32 v124, v124
    v_mfma_f32_16x16x32_bf16 v[4:7], a[32:35], v[96:99], v[4:7]
    v_rcp_f32 v125, v125
    s_waitcnt lgkmcnt(2)
    v_mfma_f32_16x16x32_bf16 v[4:7], a[40:43], v[100:103], v[4:7]
    v_mul_f32 v76, v76, v124
    v_mul_f32 v77, v77, v125
    v_cvt_pk_bf16_f32 v66, v76, v77
    v_mfma_f32_16x16x32_bf16 v[12:15], a[36:39], v[96:99], v[12:15]
    ds_read_b128 v[96:99], v117 offset:55296
    v_mul_f32 v126, v70, v70
    v_mul_f32 v127, v71, v71
    v_mfma_f32_16x16x32_bf16 v[12:15], a[44:47], v[100:103], v[12:15]
    ds_read_b128 v[100:103], v116 offset:57344
    v_fma_f32 v126, v126, s64, v123
    v_fma_f32 v127, v127, s64, v123
    v_mul_f32 v126, v126, v70
    v_mfma_f32_16x16x32_bf16 v[16:19], a[32:35], v[104:107], v[16:19]
    v_mul_f32 v127, v127, v71
    v_exp_f32 v126, v126
    s_waitcnt lgkmcnt(2)
    v_mfma_f32_16x16x32_bf16 v[16:19], a[40:43], v[108:111], v[16:19]
    v_exp_f32 v127, v127
    v_mfma_f32_16x16x32_bf16 v[24:27], a[36:39], v[104:107], v[24:27]
    ds_read_b128 v[104:107], v117 offset:57344
    v_mul_f32 v78, v70, v78
    v_mul_f32 v79, v71, v79
    v_mfma_f32_16x16x32_bf16 v[24:27], a[44:47], v[108:111], v[24:27]
    ds_read_b128 v[108:111], v116 offset:59392
    v_add_f32 v126, 1.0, v126
    v_add_f32 v127, 1.0, v127
    v_rcp_f32 v126, v126
    v_mfma_f32_16x16x32_bf16 v[20:23], a[32:35], v[112:115], v[20:23]
L_pad2:
    s_cbranch_execz L_padend
    v_rcp_f32 v127, v127
    s_waitcnt lgkmcnt(2)
    v_mfma_f32_16x16x32_bf16 v[20:23], a[40:43], v[96:99], v[20:23]
    v_mul_f32 v78, v78, v126
    v_mul_f32 v79, v79, v127
    v_mfma_f32_16x16x32_bf16 v[28:31], a[36:39], v[112:115], v[28:31]
    ds_read_b128 v[112:115], v117 offset:59392
    v_cvt_pk_bf16_f32 v67, v78, v79
    s_add_u32 s58, s62, 458752
    v_mfma_f32_16x16x32_bf16 v[28:31], a[44:47], v[96:99], v[28:31]
    ds_read_b128 v[96:99], v116 offset:61440
    v_permlane16_swap_b32 v64, v66
    v_permlane16_swap_b32 v65, v67
    buffer_store_dwordx4 v[64:67], v122, s[36:39], s58 offen sc1
    v_mfma_f32_16x16x32_bf16 v[0:3], a[48:51], v[100:103], v[0:3]
    v_mul_f32 v124, v80, v80
    v_mul_f32 v125, v81, v81
    s_waitcnt lgkmcnt(2)
    v_mfma_f32_16x16x32_bf16 v[0:3], a[56:59], v[104:107], v[0:3]
    v_fma_f32 v124, v124, s64, v123
    v_fma_f32 v125, v125, s64, v123
    v_mul_f32 v124, v124, v80
    v_mfma_f32_16x16x32_bf16 v[8:11], a[52:55], v[100:103], v[8:11]
    ds_read_b128 v[100:103], v117 offset:61440
    v_mul_f32 v125, v125, v81
    v_exp_f32 v124, v124
    v_mfma_f32_16x16x32_bf16 v[8:11], a[60:63], v[104:107], v[8:11]
    ds_read_b128 v[104:107], v116 offset:63488
    v_exp_f32 v125, v125
    v_mfma_f32_16x16x32_bf16 v[4:7], a[48:51], v[108:111], v[4:7]
    v_mul_f32 v88, v80, v88
    v_mul_f32 v89, v81, v89
    s_waitcnt lgkmcnt(2)
    v_mfma_f32_16x16x32_bf16 v[4:7], a[56:59], v[112:115], v[4:7]
    v_add_f32 v124, 1.0, v124
    v_add_f32 v125, 1.0, v125
    v_rcp_f32 v124, v124
    v_mfma_f32_16x16x32_bf16 v[12:15], a[52:55], v[108:111], v[12:15]
    ds_read_b128 v[108:111], v117 offset:63488
    v_rcp_f32 v125, v125
    v_mfma_f32_16x16x32_bf16 v[12:15], a[60:63], v[112:115], v[12:15]
    v_mul_f32 v88, v88, v124
    v_mul_f32 v89, v89, v125
    v_mfma_f32_16x16x32_bf16 v[16:19], a[48:51], v[96:99], v[16:19]
    v_cvt_pk_bf16_f32 v80, v88, v89
    v_mul_f32 v126, v82, v82
    s_waitcnt lgkmcnt(1)
    v_mfma_f32_16x16x32_bf16 v[16:19], a[56:59], v[100:103], v[16:19]
    v_mul_f32 v127, v83, v83
    v_fma_f32 v126, v126, s64, v123
    v_fma_f32 v127, v127, s64, v123
    v_mfma_f32_16x16x32_bf16 v[24:27], a[52:55], v[96:99], v[24:27]
    s_waitcnt vmcnt(1)
    s_waitcnt lgkmcnt(0)
    s_barrier
    ds_read_b128 v[112:115], v118 offset:0
    v_mul_f32 v126, v126, v82
    v_mul_f32 v127, v127, v83
    v_mfma_f32_16x16x32_bf16 v[24:27], a[60:63], v[100:103], v[24:27]
    ds_read_b128 v[96:99], v119 offset:0
    v_exp_f32 v126, v126
    v_exp_f32 v127, v127
    v_mfma_f32_16x16x32_bf16 v[20:23], a[48:51], v[104:107], v[20:23]
    ds_read_b128 v[100:103], v118 offset:2048
    v_mul_f32 v90, v82, v90
    v_mfma_f32_16x16x32_bf16 v[20:23], a[56:59], v[108:111], v[20:23]
    v_mul_f32 v91, v83, v91
    v_add_f32 v126, 1.0, v126
    v_add_f32 v127, 1.0, v127
    v_mfma_f32_16x16x32_bf16 v[28:31], a[52:55], v[104:107], v[28:31]
    ds_read_b128 v[104:107], v119 offset:2048
    v_rcp_f32 v126, v126
    v_mfma_f32_16x16x32_bf16 v[28:31], a[60:63], v[108:111], v[28:31]
    ds_read_b128 v[108:111], v118 offset:8192
    v_rcp_f32 v127, v127
    v_mul_f32 v90, v90, v126
    s_waitcnt lgkmcnt(2)
    v_mfma_f32_16x16x32_bf16 v[0:3], a[64:67], v[112:115], v[0:3]
    v_mul_f32 v91, v91, v127
    v_cvt_pk_bf16_f32 v81, v90, v91
    v_mfma_f32_16x16x32_bf16 v[0:3], a[72:75], v[96:99], v[0:3]
    v_mul_f32 v124, v84, v84
    v_mul_f32 v125, v85, v85
    v_fma_f32 v124, v124, s64, v123
    v_mfma_f32_16x16x32_bf16 v[8:11], a[68:71], v[112:115], v[8:11]
    ds_read_b128 v[112:115], v119 offset:8192
    v_fma_f32 v125, v125, s64, v123
    v_mul_f32 v124, v124, v84
    v_mfma_f32_16x16x32_bf16 v[8:11], a[76:79], v[96:99], v[8:11]
    ds_read_b128 v[96:99], v118 offset:10240
    v_mul_f32 v125, v125, v85
    v_exp_f32 v124, v124
    v_mfma_f32_16x16x32_bf16 v[4:7], a[64:67], v[100:103], v[4:7]
    v_exp_f32 v125, v125
    s_waitcnt lgkmcnt(2)
    v_mfma_f32_16x16x32_bf16 v[4:7], a[72:75], v[104:107], v[4:7]
    v_mul_f32 v92, v84, v92
    v_mul_f32 v93, v85, v93
    v_add_f32 v124, 1.0, v124
    v_mfma_f32_16x16x32_bf16 v[12:15], a[68:71], v[100:103], v[12:15]
    ds_read_b128 v[100:103], v119 offset:10240
    v_add_f32 v125, 1.0, v125
    v_rcp_f32 v124, v124
    v_mfma_f32_16x16x32_bf16 v[12:15], a[76:79], v[104:107], v[12:15]
    ds_read_b128 v[104:107], v118 offset:16384
    v_rcp_f32 v125, v125
    v_mfma_f32_16x16x32_bf16 v[0:3], a[80:83], v[108:111], v[0:3]
    v_mul_f32 v92, v92, v124
    v_mul_f32 v93, v93, v125
    s_waitcnt lgkmcnt(2)
    v_mfma_f32_16x16x32_bf16 v[0:3], a[88:91], v[112:115], v[0:3]
    v_cvt_pk_bf16_f32 v82, v92, v93
    v_mul_f32 v126, v86, v86
    v_mul_f32 v127, v87, v87
    v_mfma_f32_16x16x32_bf16 v[8:11], a[84:87], v[108:111], v[8:11]
    ds_read_b128 v[108:111], v119 offset:16384
    v_fma_f32 v126, v126, s64, v123
    v_fma_f32 v127, v127, s64, v123
    v_mfma_f32_16x16x32_bf16 v[8:11], a[92:95], v[112:115], v[8:11]
    ds_read_b128 v[112:115], v118 offset:18432
    v_mul_f32 v126, v126, v86
    v_mul_f32 v127, v127, v87
    v_exp_f32 v126, v126
    v_mfma_f32_16x16x32_bf16 v[4:7], a[80:83], v[96:99], v[4:7]
    v_exp_f32 v127, v127
    s_waitcnt lgkmcnt(2)
    v_mfma_f32_16x16x32_bf16 v[4:7], a[88:91], v[100:103], v[4:7]
    v_mul_f32 v94, v86, v94
    v_mul_f32 v95, v87, v95
    v_mfma_f32_16x16x32_bf16 v[12:15], a[84:87], v[96:99], v[12:15]
    ds_read_b128 v[96:99], v119 offset:18432
    v_add_f32 v126, 1.0, v126
    v_add_f32 v127, 1.0, v127
    v_mfma_f32_16x16x32_bf16 v[12:15], a[92:95], v[100:103], v[12:15]
    ds_read_b128 v[100:103], v118 offset:24576
    v_rcp_f32 v126, v126
    v_rcp_f32 v127, v127
    v_mfma_f32_16x16x32_bf16 v[0:3], a[96:99], v[104:107], v[0:3]
    v_mul_f32 v94, v94, v126
    v_mul_f32 v95, v95, v127
    s_waitcnt lgkmcnt(2)
    v_mfma_f32_16x16x32_bf16 v[0:3], a[104:107], v[108:111], v[0:3]
    v_cvt_pk_bf16_f32 v83, v94, v95
    s_add_u32 s58, s62, 573440
    v_mfma_f32_16x16x32_bf16 v[8:11], a[100:103], v[104:107], v[8:11]
    ds_read_b128 v[104:107], v119 offset:24576
    v_permlane16_swap_b32 v80, v82
    v_permlane16_swap_b32 v81, v83
    v_mfma_f32_16x16x32_bf16 v[8:11], a[108:111], v[108:111], v[8:11]
    ds_read_b128 v[108:111], v118 offset:26624
    buffer_store_dwordx4 v[80:83], v122, s[36:39], s58 offen sc1
    v_mfma_f32_16x16x32_bf16 v[4:7], a[96:99], v[112:115], v[4:7]
    s_waitcnt lgkmcnt(2)
    v_mfma_f32_16x16x32_bf16 v[4:7], a[104:107], v[96:99], v[4:7]
    v_mfma_f32_16x16x32_bf16 v[12:15], a[100:103], v[112:115], v[12:15]
    ds_read_b128 v[112:115], v119 offset:26624
    v_mfma_f32_16x16x32_bf16 v[12:15], a[108:111], v[96:99], v[12:15]
    ds_read_b128 v[96:99], v118 offset:4096
    v_mfma_f32_16x16x32_bf16 v[0:3], a[112:115], v[100:103], v[0:3]
    s_waitcnt lgkmcnt(2)
    v_mfma_f32_16x16x32_bf16 v[0:3], a[120:123], v[104:107], v[0:3]
    v_mfma_f32_16x16x32_bf16 v[8:11], a[116:119], v[100:103], v[8:11]
    ds_read_b128 v[100:103], v119 offset:4096
    v_mfma_f32_16x16x32_bf16 v[8:11], a[124:127], v[104:107], v[8:11]
    ds_read_b128 v[104:107], v118 offset:6144
    v_mfma_f32_16x16x32_bf16 v[4:7], a[112:115], v[108:111], v[4:7]
    s_waitcnt lgkmcnt(2)
    v_mfma_f32_16x16x32_bf16 v[4:7], a[120:123], v[112:115], v[4:7]
    v_mfma_f32_16x16x32_bf16 v[12:15], a[116:119], v[108:111], v[12:15]
    ds_read_b128 v[108:111], v119 offset:6144
    v_mfma_f32_16x16x32_bf16 v[12:15], a[124:127], v[112:115], v[12:15]
    ds_read_b128 v[112:115], v118 offset:12288
    v_mfma_f32_16x16x32_bf16 v[16:19], a[64:67], v[96:99], v[16:19]
    s_waitcnt lgkmcnt(2)
    v_mfma_f32_16x16x32_bf16 v[16:19], a[72:75], v[100:103], v[16:19]
    v_mfma_f32_16x16x32_bf16 v[24:27], a[68:71], v[96:99], v[24:27]
    ds_read_b128 v[96:99], v119 offset:12288
    v_mfma_f32_16x16x32_bf16 v[24:27], a[76:79], v[100:103], v[24:27]
    ds_read_b128 v[100:103], v118 offset:14336
    v_mfma_f32_16x16x32_bf16 v[20:23], a[64:67], v[104:107], v[20:23]
    s_waitcnt lgkmcnt(2)
    v_mfma_f32_16x16x32_bf16 v[20:23], a[72:75], v[108:111], v[20:23]
    v_mfma_f32_16x16x32_bf16 v[28:31], a[68:71], v[104:107], v[28:31]
    ds_read_b128 v[104:107], v119 offset:14336
    v_mfma_f32_16x16x32_bf16 v[28:31], a[76:79], v[108:111], v[28:31]
    ds_read_b128 v[108:111], v118 offset:20480
    v_mul_f32 v124, v0, v0
    v_mul_f32 v125, v1, v1
    v_fma_f32 v124, v124, s64, v123
    v_fma_f32 v125, v125, s64, v123
    v_mul_f32 v124, v124, v0
    v_mul_f32 v125, v125, v1
    v_mfma_f32_16x16x32_bf16 v[16:19], a[80:83], v[112:115], v[16:19]
    v_exp_f32 v124, v124
    s_waitcnt lgkmcnt(2)
    v_mfma_f32_16x16x32_bf16 v[16:19], a[88:91], v[96:99], v[16:19]
    v_exp_f32 v125, v125
    v_mul_f32 v8, v0, v8
    v_mfma_f32_16x16x32_bf16 v[24:27], a[84:87], v[112:115], v[24:27]
    ds_read_b128 v[112:115], v119 offset:20480
    v_mul_f32 v9, v1, v9
    v_add_f32 v124, 1.0, v124
    v_mfma_f32_16x16x32_bf16 v[24:27], a[92:95], v[96:99], v[24:27]
    ds_read_b128 v[96:99], v118 offset:22528
    v_add_f32 v125, 1.0, v125
    v_rcp_f32 v124, v124
    v_mfma_f32_16x16x32_bf16 v[20:23], a[80:83], v[100:103], v[20:23]
    v_rcp_f32 v125, v125
    s_waitcnt lgkmcnt(2)
    v_mfma_f32_16x16x32_bf16 v[20:23], a[88:91], v[104:107], v[20:23]
    v_mul_f32 v8, v8, v124
    v_mul_f32 v9, v9, v125
    v_cvt_pk_bf16_f32 v0, v8, v9
    v_mfma_f32_16x16x32_bf16 v[28:31], a[84:87], v[100:103], v[28:31]
    ds_read_b128 v[100:103], v119 offset:22528
    v_mul_f32 v126, v2, v2
    v_mul_f32 v127, v3, v3
    v_mfma_f32_16x16x32_bf16 v[28:31], a[92:95], v[104:107], v[28:31]
    ds_read_b128 v[104:107], v118 offset:28672
    v_fma_f32 v126, v126, s64, v123
    v_fma_f32 v127, v127, s64, v123
    v_mul_f32 v126, v126, v2
    v_mfma_f32_16x16x32_bf16 v[16:19], a[96:99], v[108:111], v[16:19]
    v_mul_f32 v127, v127, v3
    v_exp_f32 v126, v126
    s_waitcnt lgkmcnt(2)
    v_mfma_f32_16x16x32_bf16 v[16:19], a[104:107], v[112:115], v[16:19]
    v_exp_f32 v127, v127
    v_mfma_f32_16x16x32_bf16 v[24:27], a[100:103], v[108:111], v[24:27]
    ds_read_b128 v[108:111], v119 offset:28672
    v_mul_f32 v10, v2, v10
    v_mul_f32 v11, v3, v11
    v_mfma_f32_16x16x32_bf16 v[24:27], a[108:111], v[112:115], v[24:27]
    ds_read_b128 v[112:115], v118 offset:30720
    v_add_f32 v126, 1.0, v126
    v_add_f32 v127, 1.0, v127
    v_rcp_f32 v126, v126
    v_mfma_f32_16x16x32_bf16 v[20:23], a[96:99], v[96:99], v[20:23]
    v_rcp_f32 v127, v127
    s_waitcnt lgkmcnt(2)
    v_mfma_f32_16x16x32_bf16 v[20:23], a[104:107], v[100:103], v[20:23]
    v_mul_f32 v10, v10, v126
    v_mul_f32 v11, v11, v127
    v_mfma_f32_16x16x32_bf16 v[28:31], a[100:103], v[96:99], v[28:31]
    ds_read_b128 v[96:99], v119 offset:30720
    v_cvt_pk_bf16_f32 v1, v10, v11
    v_mul_f32 v124, v4, v4
    v_mfma_f32_16x16x32_bf16 v[28:31], a[108:111], v[100:103], v[28:31]
    v_mul_f32 v125, v5, v5
    v_fma_f32 v124, v124, s64, v123
    v_fma_f32 v125, v125, s64, v123
    v_mfma_f32_16x16x32_bf16 v[16:19], a[112:115], v[104:107], v[16:19]
    v_mul_f32 v124, v124, v4
    v_mul_f32 v125, v125, v5
    s_waitcnt lgkmcnt(1)
    v_mfma_f32_16x16x32_bf16 v[16:19], a[120:123], v[108:111], v[16:19]
    v_exp_f32 v124, v124
    v_exp_f32 v125, v125
    v_mfma_f32_16x16x32_bf16 v[24:27], a[116:119], v[104:107], v[24:27]
    v_mul_f32 v12, v4, v12
    v_mul_f32 v13, v5, v13
    v_mfma_f32_16x16x32_bf16 v[24:27], a[124:127], v[108:111], v[24:27]
    v_add_f32 v124, 1.0, v124
    v_add_f32 v125, 1.0, v125
    v_mfma_f32_16x16x32_bf16 v[20:23], a[112:115], v[112:115], v[20:23]
    v_rcp_f32 v124, v124
    s_waitcnt lgkmcnt(0)
    v_mfma_f32_16x16x32_bf16 v[20:23], a[120:123], v[96:99], v[20:23]
    v_rcp_f32 v125, v125
    v_mul_f32 v12, v12, v124
    v_mfma_f32_16x16x32_bf16 v[28:31], a[116:119], v[112:115], v[28:31]
    v_mul_f32 v13, v13, v125
    v_cvt_pk_bf16_f32 v2, v12, v13
    v_mfma_f32_16x16x32_bf16 v[28:31], a[124:127], v[96:99], v[28:31]
    v_mul_f32 v126, v6, v6
    v_mul_f32 v127, v7, v7
    v_fma_f32 v126, v126, s64, v123
    s_waitcnt vmcnt(0)
    s_add_u32 s15, s63, 8704
    s_atomic_add s14, s[36:37], s15
    v_fma_f32 v127, v127, s64, v123
    v_mul_f32 v126, v126, v6
    v_mul_f32 v127, v127, v7
    v_exp_f32 v126, v126
    v_exp_f32 v127, v127
    v_mul_f32 v14, v6, v14
    v_mul_f32 v15, v7, v15
    v_add_f32 v126, 1.0, v126
    v_add_f32 v127, 1.0, v127
    v_rcp_f32 v126, v126
    v_rcp_f32 v127, v127
    v_mul_f32 v14, v14, v126
    v_mul_f32 v15, v15, v127
    v_cvt_pk_bf16_f32 v3, v14, v15
    s_add_u32 s58, s62, 688128
    v_permlane16_swap_b32 v0, v2
    v_permlane16_swap_b32 v1, v3
    buffer_store_dwordx4 v[0:3], v122, s[36:39], s58 offen sc1
    v_pk_mul_f32 v[124:125], v[16:17], v[16:17]
    v_pk_mul_f32 v[126:127], v[18:19], v[18:19]
    v_pk_fma_f32 v[124:125], v[124:125], s[64:65], v[122:123] op_sel:[0,0,1] op_sel_hi:[1,0,1]
    v_pk_fma_f32 v[126:127], v[126:127], s[64:65], v[122:123] op_sel:[0,0,1] op_sel_hi:[1,0,1]
    v_pk_mul_f32 v[124:125], v[124:125], v[16:17]
    v_pk_mul_f32 v[126:127], v[126:127], v[18:19]
    v_exp_f32 v124, v124
    v_exp_f32 v125, v125
    v_exp_f32 v126, v126
    v_exp_f32 v127, v127
    v_pk_mul_f32 v[24:25], v[16:17], v[24:25]
    v_pk_mul_f32 v[26:27], v[18:19], v[26:27]
    v_pk_add_f32 v[124:125], v[124:125], 1.0 op_sel_hi:[1,0]
    v_pk_add_f32 v[126:127], v[126:127], 1.0 op_sel_hi:[1,0]
    v_rcp_f32 v124, v124
    v_rcp_f32 v125, v125
    v_rcp_f32 v126, v126
    v_rcp_f32 v127, v127
    v_pk_mul_f32 v[24:25], v[24:25], v[124:125]
    v_pk_mul_f32 v[26:27], v[26:27], v[126:127]
    v_cvt_pk_bf16_f32 v16, v24, v25
    v_cvt_pk_bf16_f32 v17, v26, v27
    v_pk_mul_f32 v[124:125], v[20:21], v[20:21]
    v_pk_mul_f32 v[126:127], v[22:23], v[22:23]
    v_pk_fma_f32 v[124:125], v[124:125], s[64:65], v[122:123] op_sel:[0,0,1] op_sel_hi:[1,0,1]
    v_pk_fma_f32 v[126:127], v[126:127], s[64:65], v[122:123] op_sel:[0,0,1] op_sel_hi:[1,0,1]
    v_pk_mul_f32 v[124:125], v[124:125], v[20:21]
    v_pk_mul_f32 v[126:127], v[126:127], v[22:23]
    v_exp_f32 v124, v124
    v_exp_f32 v125, v125
    v_exp_f32 v126, v126
    v_exp_f32 v127, v127
    v_pk_mul_f32 v[28:29], v[20:21], v[28:29]
    v_pk_mul_f32 v[30:31], v[22:23], v[30:31]
    v_pk_add_f32 v[124:125], v[124:125], 1.0 op_sel_hi:[1,0]
    v_pk_add_f32 v[126:127], v[126:127], 1.0 op_sel_hi:[1,0]
    v_rcp_f32 v124, v124
    v_rcp_f32 v125, v125
    v_rcp_f32 v126, v126
    v_rcp_f32 v127, v127
    v_pk_mul_f32 v[28:29], v[28:29], v[124:125]
    v_pk_mul_f32 v[30:31], v[30:31], v[126:127]
    v_cvt_pk_bf16_f32 v18, v28, v29
    v_cvt_pk_bf16_f32 v19, v30, v31
    s_add_u32 s58, s62, 802816
    v_permlane16_swap_b32 v16, v18
    v_permlane16_swap_b32 v17, v19
    buffer_store_dwordx4 v[16:19], v122, s[36:39], s58 offen sc1
    s_waitcnt vmcnt(0)
    s_add_u32 s15, s63, 13056
    s_atomic_add s14, s[36:37], s15
L_p1_join:
    s_setprio 0
    v_mbcnt_lo_u32_b32 v127, -1, 0
    v_mbcnt_hi_u32_b32 v127, -1, v127
    v_lshrrev_b32 v1, 4, v127
    s_lshl_b32 s56, s60, 2
    v_add_u32 v1, s56, v1
    v_and_b32 v2, 15, v127
    v_xor_b32 v3, v2, v1
    v_lshlrev_b32 v3, 4, v3
    v_lshl_add_u32 v3, v1, 8, v3
    v_lshlrev_b32 v4, 10, v1
    v_lshl_add_u32 v4, v2, 3, v4
    s_lshl_b32 s56, s48, 18
    s_lshl_b32 s57, s55, 7
    s_add_u32 s56, s56, s57
    s_lshl_b32 s58, s54, 14
    s_add_u32 s68, s58, s56
    s_add_u32 s69, s68, 65536
    s_add_u32 s70, s68, 131072
    s_add_u32 s71, s68, 196608
    s_barrier
    ds_read_b128 v[8:11], v3 offset:0
    ds_read_b128 v[12:15], v3 offset:4096
    ds_read_b128 v[16:19], v3 offset:8192
    ds_read_b128 v[20:23], v3 offset:12288
    ds_read_b128 v[24:27], v3 offset:16384
    ds_read_b128 v[28:31], v3 offset:20480
    ds_read_b128 v[32:35], v3 offset:24576
    ds_read_b128 v[36:39], v3 offset:28672
    ds_read_b128 v[40:43], v3 offset:32768
    ds_read_b128 v[44:47], v3 offset:36864
    ds_read_b128 v[48:51], v3 offset:40960
    ds_read_b128 v[52:55], v3 offset:45056
    s_waitcnt lgkmcnt(10)
    v_add_f32 v8, v8, v12
    v_add_f32 v9, v9, v13
    v_add_f32 v10, v10, v14
    v_add_f32 v11, v11, v15
    s_waitcnt lgkmcnt(8)
    v_add_f32 v16, v16, v20
    v_add_f32 v17, v17, v21
    v_add_f32 v18, v18, v22
    v_add_f32 v19, v19, v23
    v_add_f32 v8, v8, v16
    v_add_f32 v9, v9, v17
    v_add_f32 v10, v10, v18
    v_add_f32 v11, v11, v19
    v_cvt_pk_bf16_f32 v12, v8, v9
    v_cvt_pk_bf16_f32 v13, v10, v11
    buffer_store_dwordx2 v[12:13], v4, s[40:43], s68 offen sc1
    s_waitcnt lgkmcnt(6)
    v_add_f32 v24, v24, v28
    v_add_f32 v25, v25, v29
    v_add_f32 v26, v26, v30
    v_add_f32 v27, v27, v31
    s_waitcnt lgkmcnt(4)
    v_add_f32 v32, v32, v36
    v_add_f32 v33, v33, v37
    v_add_f32 v34, v34, v38
    v_add_f32 v35, v35, v39
    v_add_f32 v24, v24, v32
    v_add_f32 v25, v25, v33
    v_add_f32 v26, v26, v34
    v_add_f32 v27, v27, v35
    v_cvt_pk_bf16_f32 v28, v24, v25
    v_cvt_pk_bf16_f32 v29, v26, v27
    buffer_store_dwordx2 v[28:29], v4, s[40:43], s69 offen sc1
    s_waitcnt lgkmcnt(2)
    v_add_f32 v40, v40, v44
    v_add_f32 v41, v41, v45
    v_add_f32 v42, v42, v46
    v_add_f32 v43, v43, v47
    s_waitcnt lgkmcnt(0)
    v_add_f32 v48, v48, v52
    v_add_f32 v49, v49, v53
    v_add_f32 v50, v50, v54
    v_add_f32 v51, v51, v55
    v_add_f32 v40, v40, v48
    v_add_f32 v41, v41, v49
    v_add_f32 v42, v42, v50
    v_add_f32 v43, v43, v51
    v_cvt_pk_bf16_f32 v44, v40, v41
    v_cvt_pk_bf16_f32 v45, v42, v43
    buffer_store_dwordx2 v[44:45], v4, s[40:43], s70 offen sc1
    s_setprio 2
    s_barrier
    ds_read_b128 v[56:59], v3 offset:49152
    ds_read_b128 v[60:63], v3 offset:53248
    ds_read_b128 v[64:67], v3 offset:57344
    ds_read_b128 v[68:71], v3 offset:61440
    s_waitcnt lgkmcnt(2)
    v_pk_add_f32 v[56:57], v[56:57], v[60:61]
    v_pk_add_f32 v[58:59], v[58:59], v[62:63]
    s_waitcnt lgkmcnt(0)
    v_pk_add_f32 v[64:65], v[64:65], v[68:69]
    v_pk_add_f32 v[66:67], v[66:67], v[70:71]
    v_pk_add_f32 v[56:57], v[56:57], v[64:65]
    v_pk_add_f32 v[58:59], v[58:59], v[66:67]
    v_cvt_pk_bf16_f32 v60, v56, v57
    v_cvt_pk_bf16_f32 v61, v58, v59
    buffer_store_dwordx2 v[60:61], v4, s[40:43], s71 offen sc1
    s_endpgm
L_p1_idle:
    s_cmp_lg_u32 s60, 0
    s_cbranch_scc1 L_idle_pf
    s_lshl_b32 s57, s48, 2
    s_add_u32 s57, s57, s49
    s_mul_i32 s57, s57, 17408
    v_mul_u32_u24 v1, 4352, v127
    v_mov_b32 v2, 0
    s_mov_b64 exec, 15
    buffer_store_dword v2, v1, s[36:39], s57 offen sc1
    s_mov_b64 exec, -1
    s_waitcnt vmcnt(0)
    s_mov_b32 s57, 1
    s_atomic_add s57, s[44:45], 128 glc
    s_waitcnt lgkmcnt(0)
    s_cmp_lg_u32 s57, 31
    s_cbranch_scc1 L_irdy_retry
    s_atomic_add s14, s[44:45], 0
L_irdy_ok:
    s_branch L_idle_done
L_idle_pf:
    v_lshlrev_b32 v1, 7, v127
    s_cmp_lg_u32 s60, 1
    s_cbranch_scc1 L_idle_done
    s_mul_i32 s59, s48, 2
    s_sub_u32 s57, s59, 14
    s_cselect_b32 s59, s59, s57
    s_lshr_b32 s56, s48, 1
    s_add_u32 s56, s56, 0
    s_and_b32 s56, s56, 3
    s_lshl_b32 s56, s56, 15
    s_lshl_b32 s58, s50, 18
    s_add_u32 s56, s56, s58
    s_add_u32 s58, s56, 131072
    s_waitcnt vmcnt(0)
    buffer_load_dword v8, v1, s[20:23], s58 offen
    s_add_u32 s58, s56, 139264
    s_waitcnt vmcnt(2)
    buffer_load_dword v8, v1, s[20:23], s58 offen
    s_add_u32 s58, s56, 147456
    s_waitcnt vmcnt(2)
    buffer_load_dword v8, v1, s[20:23], s58 offen
    s_add_u32 s58, s56, 155648
    s_waitcnt vmcnt(2)
    buffer_load_dword v8, v1, s[20:23], s58 offen
    s_add_u32 s56, s59, 0
    s_sub_u32 s58, s56, 14
    s_cselect_b32 s56, s56, s58
    s_mul_i32 s58, s49, 14
    s_add_u32 s56, s56, s58
    s_lshl_b32 s56, s56, 15
    s_add_u32 s58, s56, 0
    s_waitcnt vmcnt(2)
    buffer_load_dword v8, v1, s[32:35], s58 offen
    s_add_u32 s58, s56, 8192
    s_waitcnt vmcnt(2)
    buffer_load_dword v8, v1, s[32:35], s58 offen
    s_add_u32 s58, s56, 16384
    s_waitcnt vmcnt(2)
    buffer_load_dword v8, v1, s[32:35], s58 offen
    s_add_u32 s58, s56, 24576
    s_waitcnt vmcnt(2)
    buffer_load_dword v8, v1, s[32:35], s58 offen
    s_add_u32 s56, s59, 1
    s_sub_u32 s58, s56, 14
    s_cselect_b32 s56, s56, s58
    s_mul_i32 s58, s49, 14
    s_add_u32 s56, s56, s58
    s_lshl_b32 s56, s56, 15
    s_add_u32 s58, s56, 0
    s_waitcnt vmcnt(2)
    buffer_load_dword v8, v1, s[32:35], s58 offen
    s_add_u32 s58, s56, 8192
    s_waitcnt vmcnt(2)
    buffer_load_dword v8, v1, s[32:35], s58 offen
    s_add_u32 s58, s56, 16384
    s_waitcnt vmcnt(2)
    buffer_load_dword v8, v1, s[32:35], s58 offen
    s_add_u32 s58, s56, 24576
    s_waitcnt vmcnt(2)
    buffer_load_dword v8, v1, s[32:35], s58 offen
    s_add_u32 s56, s59, 8
    s_sub_u32 s58, s56, 14
    s_cselect_b32 s56, s56, s58
    s_mul_i32 s58, s49, 14
    s_add_u32 s56, s56, s58
    s_lshl_b32 s56, s56, 15
    s_add_u32 s58, s56, 0
    s_waitcnt vmcnt(4)
    buffer_load_dword v8, v1, s[32:35], s58 offen
    s_add_u32 s58, s56, 8192
    s_waitcnt vmcnt(4)
    buffer_load_dword v8, v1, s[32:35], s58 offen
    s_add_u32 s58, s56, 16384
    s_waitcnt vmcnt(4)
    buffer_load_dword v8, v1, s[32:35], s58 offen
    s_add_u32 s58, s56, 24576
    s_waitcnt vmcnt(4)
    buffer_load_dword v8, v1, s[32:35], s58 offen
    s_add_u32 s56, s59, 9
    s_sub_u32 s58, s56, 14
    s_cselect_b32 s56, s56, s58
    s_mul_i32 s58, s49, 14
    s_add_u32 s56, s56, s58
    s_lshl_b32 s56, s56, 15
    s_add_u32 s58, s56, 0
    s_waitcnt vmcnt(4)
    buffer_load_dword v8, v1, s[32:35], s58 offen
    s_add_u32 s58, s56, 8192
    s_waitcnt vmcnt(4)
    buffer_load_dword v8, v1, s[32:35], s58 offen
    s_add_u32 s58, s56, 16384
    s_waitcnt vmcnt(4)
    buffer_load_dword v8, v1, s[32:35], s58 offen
    s_add_u32 s58, s56, 24576
    s_waitcnt vmcnt(4)
    buffer_load_dword v8, v1, s[32:35], s58 offen
    s_add_u32 s56, s59, 10
    s_sub_u32 s58, s56, 14
    s_cselect_b32 s56, s56, s58
    s_mul_i32 s58, s49, 14
    s_add_u32 s56, s56, s58
    s_lshl_b32 s56, s56, 15
    s_add_u32 s58, s56, 0
    s_waitcnt vmcnt(4)
    buffer_load_dword v8, v1, s[32:35], s58 offen
    s_add_u32 s58, s56, 8192
    s_waitcnt vmcnt(4)
    buffer_load_dword v8, v1, s[32:35], s58 offen
    s_add_u32 s58, s56, 16384
    s_waitcnt vmcnt(4)
    buffer_load_dword v8, v1, s[32:35], s58 offen
    s_add_u32 s58, s56, 24576
    s_waitcnt vmcnt(4)
    buffer_load_dword v8, v1, s[32:35], s58 offen
    s_add_u32 s56, s59, 11
    s_sub_u32 s58, s56, 14
    s_cselect_b32 s56, s56, s58
    s_mul_i32 s58, s49, 14
    s_add_u32 s56, s56, s58
    s_lshl_b32 s56, s56, 15
    s_add_u32 s58, s56, 0
    s_waitcnt vmcnt(4)
    buffer_load_dword v8, v1, s[32:35], s58 offen
    s_add_u32 s58, s56, 8192
    s_waitcnt vmcnt(4)
    buffer_load_dword v8, v1, s[32:35], s58 offen
    s_add_u32 s58, s56, 16384
    s_waitcnt vmcnt(4)
    buffer_load_dword v8, v1, s[32:35], s58 offen
    s_add_u32 s58, s56, 24576
    s_waitcnt vmcnt(4)
    buffer_load_dword v8, v1, s[32:35], s58 offen
    s_add_u32 s56, s59, 12
    s_sub_u32 s58, s56, 14
    s_cselect_b32 s56, s56, s58
    s_mul_i32 s58, s49, 14
    s_add_u32 s56, s56, s58
    s_lshl_b32 s56, s56, 15
    s_add_u32 s58, s56, 0
    s_waitcnt vmcnt(4)
    buffer_load_dword v8, v1, s[32:35], s58 offen
    s_add_u32 s58, s56, 8192
    s_waitcnt vmcnt(4)
    buffer_load_dword v8, v1, s[32:35], s58 offen
    s_add_u32 s58, s56, 16384
    s_waitcnt vmcnt(4)
    buffer_load_dword v8, v1, s[32:35], s58 offen
    s_add_u32 s58, s56, 24576
    s_waitcnt vmcnt(4)
    buffer_load_dword v8, v1, s[32:35], s58 offen
    s_add_u32 s56, s59, 13
    s_sub_u32 s58, s56, 14
    s_cselect_b32 s56, s56, s58
    s_mul_i32 s58, s49, 14
    s_add_u32 s56, s56, s58
    s_lshl_b32 s56, s56, 15
    s_add_u32 s58, s56, 0
    s_waitcnt vmcnt(4)
    buffer_load_dword v8, v1, s[32:35], s58 offen
    s_add_u32 s58, s56, 8192
    s_waitcnt vmcnt(4)
    buffer_load_dword v8, v1, s[32:35], s58 offen
    s_add_u32 s58, s56, 16384
    s_waitcnt vmcnt(4)
    buffer_load_dword v8, v1, s[32:35], s58 offen
    s_add_u32 s58, s56, 24576
    s_waitcnt vmcnt(4)
    buffer_load_dword v8, v1, s[32:35], s58 offen
    v_lshlrev_b32 v2, 10, v127
    s_add_u32 s56, s59, 2
    s_sub_u32 s58, s56, 14
    s_cselect_b32 s56, s56, s58
    s_mul_i32 s58, s49, 14
    s_add_u32 s56, s56, s58
    s_lshl_b32 s56, s56, 15
    s_waitcnt vmcnt(2)
    buffer_load_dword v8, v2, s[32:35], s56 offen offset:384
    s_add_u32 s56, s59, 4
    s_sub_u32 s58, s56, 14
    s_cselect_b32 s56, s56, s58
    s_mul_i32 s58, s49, 14
    s_add_u32 s56, s56, s58
    s_lshl_b32 s56, s56, 15
    s_waitcnt vmcnt(2)
    buffer_load_dword v8, v2, s[32:35], s56 offen offset:384
    s_add_u32 s56, s59, 6
    s_sub_u32 s58, s56, 14
    s_cselect_b32 s56, s56, s58
    s_mul_i32 s58, s49, 14
    s_add_u32 s56, s56, s58
    s_lshl_b32 s56, s56, 15
    s_waitcnt vmcnt(2)
    buffer_load_dword v8, v2, s[32:35], s56 offen offset:384
L_idle_done:
    s_barrier
    s_waitcnt vmcnt(0)
    s_branch L_p1_join
L_irdy_retry:
    s_mov_b32 s61, 65536
L_irdy_loop:
    s_sub_u32 s61, s61, 1
    s_cbranch_scc1 L_irdy_ok
    v_mov_b32 v9, 0
    buffer_load_dword v9, v9, s[44:47], 0 offen sc1
    s_waitcnt vmcnt(0)
    v_cmp_ne_u32 vcc, 1, v9
    s_cbranch_vccz L_irdy_ok
    s_sleep 2
    s_branch L_irdy_loop
L_exit:
    s_endpgm
.section .rodata,"a"
.p2align 6
.amdhsa_kernel standalone__glu_gated_geglu__prompt_kernel
  .amdhsa_next_free_vgpr 256
  .amdhsa_next_free_sgpr 102
  .amdhsa_accum_offset 128
  .amdhsa_group_segment_fixed_size 0
  .amdhsa_kernarg_size 56
  .amdhsa_user_sgpr_count 2
  .amdhsa_user_sgpr_kernarg_segment_ptr 1
  .amdhsa_system_sgpr_workgroup_id_x 1
  .amdhsa_float_denorm_mode_32 3
.end_amdhsa_kernel
```
